```python
import torch

def _softmax(x, axis=-1):
    return torch.softmax(x, dim=axis)
def _gelu(x):
    return torch.nn.functional.gelu(x, approximate="tanh")
def _silu(x):
    return torch.nn.functional.silu(x)
def _sigmoid(x):
    return torch.sigmoid(x)
def _layernorm(x, axis=-1, eps=1e-5):
    m = x.mean(dim=axis, keepdim=True)
    v = x.var(dim=axis, keepdim=True, unbiased=False)
    return (x - m) / torch.sqrt(v + eps)
def _scatter_add(tgt, idx, src, axis=0):
    return tgt.clone().index_add_(axis, idx, src)
def _segment_sum(src, seg, n):
    out = torch.zeros((n,) + src.shape[1:], dtype=src.dtype)
    return out.index_add_(0, seg, src)
def _pad(x, pw):
    flat = tuple(v for pair in reversed(pw) for v in pair)
    return torch.nn.functional.pad(x, flat)

kernel_name = 'concat_heads__gqa_block_cached__gqa_block_cached__near_ridge'

def setup_inputs():

    _w = (lambda a: (lambda t: t.to(torch.bfloat16) if t.is_floating_point() else t)(torch.as_tensor(a)))
    def _A_setup():
        B, Sq, D = 8, 64, 448
        Hq, Hkv, Sk, Dh = 16, 8, 512, 256
        assert Hq % Hkv == 0, (Hq, Hkv)
        return {
            "x": _w((lambda *s: torch.randn(*s, dtype=torch.bfloat16) * 0.8)(B, Sq, D)),
            "k_cache": _w((lambda *s: torch.randn(*s, dtype=torch.bfloat16) * 0.8)(B, Hkv, Sk, Dh)),
            "v_cache": _w((lambda *s: torch.randn(*s, dtype=torch.bfloat16) * 0.05)(B, Hkv, Sk, Dh)),
            "wq": _w((lambda *s: torch.randn(*s, dtype=torch.bfloat16) * 0.8)(D, Hq * Dh) * (D ** -0.5)),
            "wo": _w((lambda *s: torch.randn(*s, dtype=torch.bfloat16) * 0.05)(Hq * Dh, D) * ((Hq * Dh) ** -0.5)),
        }
    _A_in = _A_setup()

    def _B_setup():
        B, Sq, D = 8, 64, 448
        Hq, Hkv, Sk, Dh = 16, 8, 512, 256
        assert Hq % Hkv == 0, (Hq, Hkv)
        return {
            "x": _w((lambda *s: torch.randn(*s, dtype=torch.bfloat16) * 0.8)(B, Sq, D)),
            "k_cache": _w((lambda *s: torch.randn(*s, dtype=torch.bfloat16) * 0.8)(B, Hkv, Sk, Dh)),
            "v_cache": _w((lambda *s: torch.randn(*s, dtype=torch.bfloat16) * 0.05)(B, Hkv, Sk, Dh)),
            "wq": _w((lambda *s: torch.randn(*s, dtype=torch.bfloat16) * 0.8)(D, Hq * Dh) * (D ** -0.5)),
            "wo": _w((lambda *s: torch.randn(*s, dtype=torch.bfloat16) * 0.05)(Hq * Dh, D) * ((Hq * Dh) ** -0.5)),
        }
    _B_in = _B_setup()

    return {
        "A_x": _A_in["x"],
        "A_k_cache": _A_in["k_cache"],
        "A_v_cache": _A_in["v_cache"],
        "A_wq": _A_in["wq"],
        "A_wo": _A_in["wo"],
        "B_x": _B_in["x"],
        "B_k_cache": _B_in["k_cache"],
        "B_v_cache": _B_in["v_cache"],
        "B_wq": _B_in["wq"],
        "B_wo": _B_in["wo"],
    }

def reference(A_x, A_k_cache, A_v_cache, A_wq, A_wo, B_x, B_k_cache, B_v_cache, B_wq, B_wo):
    def _A_ref(x, k_cache, v_cache, wq, wo):
        B, Sq, D = x.shape
        Hq, Dh = 16, 256
        Hkv = k_cache.shape[1]
        rep = Hq // Hkv
        q = (lambda x, *d: x.permute(*d))((x @ wq).reshape(B, Sq, Hq, Dh), 0, 2, 1, 3)
        k = (lambda x, n, axis: torch.repeat_interleave(x, n, dim=axis))(k_cache, rep, axis=1)
        v = (lambda x, n, axis: torch.repeat_interleave(x, n, dim=axis))(v_cache, rep, axis=1)
        scores = torch.einsum("bhqd,bhkd->bhqk", q, k) * (Dh ** -0.5)
        p = _softmax(scores, axis=-1)
        o = torch.einsum("bhqk,bhkd->bhqd", p, v)
        return (lambda x, *d: x.permute(*d))(o, 0, 2, 1, 3).reshape(B, Sq, Hq * Dh) @ wo

    def _B_ref(x, k_cache, v_cache, wq, wo):
        B, Sq, D = x.shape
        Hq, Dh = 16, 256
        Hkv = k_cache.shape[1]
        rep = Hq // Hkv
        q = (lambda x, *d: x.permute(*d))((x @ wq).reshape(B, Sq, Hq, Dh), 0, 2, 1, 3)
        k = (lambda x, n, axis: torch.repeat_interleave(x, n, dim=axis))(k_cache, rep, axis=1)
        v = (lambda x, n, axis: torch.repeat_interleave(x, n, dim=axis))(v_cache, rep, axis=1)
        scores = torch.einsum("bhqd,bhkd->bhqk", q, k) * (Dh ** -0.5)
        p = _softmax(scores, axis=-1)
        o = torch.einsum("bhqk,bhkd->bhqd", p, v)
        return (lambda x, *d: x.permute(*d))(o, 0, 2, 1, 3).reshape(B, Sq, Hq * Dh) @ wo

    a = _A_ref(A_x, A_k_cache, A_v_cache, A_wq, A_wo)
    b = _B_ref(B_x, B_k_cache, B_v_cache, B_wq, B_wo)
    return torch.concatenate([a, b], axis=-1)
```

```asm
; @launch grid=(256,1,1) block=(256,1,1) lds=163840
.amdgcn_target "amdgcn-amd-amdhsa--gfx950"
.text
.globl concat_heads__gqa_block_cached__gqa_block_cached__near_ridge_kernel
.p2align 8
.type concat_heads__gqa_block_cached__gqa_block_cached__near_ridge_kernel,@function
concat_heads__gqa_block_cached__gqa_block_cached__near_ridge_kernel:
s_cmp_ge_u32 s2, 256
s_cbranch_scc1 L_main_end
s_load_dwordx16 s[76:91], s[0:1], 0
s_load_dwordx4 s[92:95], s[0:1], 64
s_load_dwordx4 s[36:39], s[0:1], 80
s_load_dwordx2 s[96:97], s[0:1], 96
s_and_b32 s3, s2, 7
s_lshr_b32 s4, s2, 3
s_lshr_b32 s5, s3, 2
s_and_b32 s6, s3, 3
s_bfe_u32 s7, s4, 0x30001
s_lshl_b32 s6, s6, 2
s_lshr_b32 s3, s4, 4
s_add_u32 s6, s6, s3
s_and_b32 s4, s4, 1
s_lshl_b32 s4, s4, 1
s_add_u32 s6, s6, s4
v_lshrrev_b32 v1, 6, v0
v_and_b32 v0, 63, v0
s_nop 0
v_readfirstlane_b32 s9, v1
s_mov_b32 s43, 0
v_lshrrev_b32 v38, 3, v0
v_and_b32 v39, 7, v0
v_lshrrev_b32 v40, 4, v0
s_mul_i32 s40, s9, 24576
s_lshl_b32 s48, s9, 10
s_lshl_b32 s10, s9, 2
v_add_u32 v41, s10, v40
v_and_b32 v41, 7, v41
v_xor_b32 v41, v41, v39
v_lshlrev_b32 v41, 4, v41
s_lshl_b32 s10, s9, 3
v_add_u32 v42, s10, v38
v_mul_u32_u24 v42, 896, v42
v_add_u32 v1, v42, v41
v_and_b32 v41, 1, v40
v_lshlrev_b32 v41, 2, v41
v_xor_b32 v41, v41, v39
v_lshlrev_b32 v41, 4, v41
s_lshl_b32 s10, s9, 7
v_add_u32 v43, s10, v41
v_lshl_add_u32 v2, v38, 13, v43
v_add_u32 v3, 64512, v2
v_add_u32 v4, 129024, v2
v_add_u32 v5, 193536, v2
v_lshl_add_u32 v10, v38, 9, v43
v_add_u32 v11, 3072, v10
v_add_u32 v12, 6144, v10
v_add_u32 v13, 9216, v10
v_mul_u32_u24 v42, 896, v38
s_lshl_b32 s10, s9, 8
v_add3_u32 v14, v42, v41, s10
v_add_u32 v15, 6144, v14
v_add_u32 v16, 12288, v14
v_add_u32 v17, 18432, v14
v_xor_b32 v41, v40, v39
v_lshlrev_b32 v41, 4, v41
v_lshl_add_u32 v41, v38, 9, v41
s_lshl_b32 s10, s9, 16
v_add_u32 v6, s10, v41
v_xor_b32 v41, 64, v6
v_add_u32 v7, 3072, v41
v_add_u32 v8, 6144, v6
v_add_u32 v9, 9216, v41
v_and_b32 v43, 31, v0
v_lshrrev_b32 v44, 5, v0
v_bfe_u32 v45, v0, 1, 3
v_xor_b32 v45, v45, v44
v_lshlrev_b32 v45, 4, v45
v_lshl_add_u32 v45, v43, 7, v45
v_add_u32 v18, s40, v45
v_xor_b32 v19, 32, v18
v_xor_b32 v20, 64, v18
v_xor_b32 v21, 96, v18
v_bfe_u32 v46, v0, 2, 2
v_and_b32 v47, 3, v0
v_and_b32 v38, 1, v0
v_lshlrev_b32 v38, 1, v38
v_bfe_u32 v39, v0, 1, 1
v_or_b32 v38, v38, v39
v_bfe_u32 v39, v0, 4, 1
v_lshlrev_b32 v39, 5, v39
v_lshrrev_b32 v40, 1, v46
v_lshlrev_b32 v40, 6, v40
v_lshlrev_b32 v41, 7, v46
v_add3_u32 v41, v41, v40, v39
v_add_u32 v41, s40, v41
v_lshl_add_u32 v42, v38, 3, v41
v_lshl_add_u32 v22, v44, 10, v42
v_xor_b32 v23, 64, v22
v_lshl_add_u32 v26, v44, 9, v42
v_xor_b32 v27, 64, v26
v_lshl_add_u32 v42, v47, 3, v41
v_lshl_add_u32 v24, v44, 9, v42
v_xor_b32 v25, 64, v24
v_lshlrev_b32 v38, 4, v0
v_add_u32 v28, 98304, v38
s_lshl_b32 s10, s9, 13
v_add_u32 v29, s10, v28
s_lshl_b32 s10, s9, 12
v_add_u32 v30, s10, v28
v_lshlrev_b32 v39, 5, v43
v_add_u32 v32, 98304, v39
s_lshl_b32 s10, s9, 3
v_lshl_add_u32 v31, v44, 2, v32
v_add_u32 v31, s10, v31
s_lshl_b32 s10, s9, 14
v_add_u32 v33, s10, v38
v_mov_b32 v96, 0
v_mov_b32 v97, 0
v_mov_b32 v98, 0
v_mov_b32 v99, 0
v_mov_b32 v100, 0
v_mov_b32 v101, 0
v_mov_b32 v102, 0
v_mov_b32 v103, 0
v_mov_b32 v104, 0
v_mov_b32 v105, 0
v_mov_b32 v106, 0
v_mov_b32 v107, 0
v_mov_b32 v108, 0
v_mov_b32 v109, 0
v_mov_b32 v110, 0
v_mov_b32 v111, 0
v_mov_b32 v112, 0
v_mov_b32 v113, 0
v_mov_b32 v114, 0
v_mov_b32 v115, 0
v_mov_b32 v116, 0
v_mov_b32 v117, 0
v_mov_b32 v118, 0
v_mov_b32 v119, 0
v_mov_b32 v120, 0
v_mov_b32 v121, 0
v_mov_b32 v122, 0
v_mov_b32 v123, 0
v_mov_b32 v124, 0
v_mov_b32 v125, 0
v_mov_b32 v126, 0
v_mov_b32 v127, 0
s_waitcnt lgkmcnt(0)
s_cmp_eq_u32 s5, 0
s_cselect_b32 s12, s76, s86
s_cselect_b32 s13, s77, s87
s_mov_b32 s15, 0x00020000
s_cselect_b32 s16, s82, s92
s_cselect_b32 s17, s83, s93
s_mov_b32 s19, 0x00020000
s_cselect_b32 s20, s78, s88
s_cselect_b32 s21, s79, s89
s_mov_b32 s23, 0x00020000
s_cselect_b32 s24, s80, s90
s_cselect_b32 s25, s81, s91
s_mov_b32 s27, 0x00020000
s_cselect_b32 s28, s84, s94
s_cselect_b32 s29, s85, s95
s_mov_b32 s31, 0x00020000
s_mul_i32 s10, s7, 57344
s_add_u32 s12, s12, s10
s_addc_u32 s13, s13, 0
s_mov_b32 s14, 57344
s_lshl_b32 s10, s6, 9
s_add_u32 s16, s16, s10
s_addc_u32 s17, s17, 0
s_sub_u32 s18, 3670016, s10
s_cmp_eq_u32 s7, 7
s_cselect_b32 s49, 0, s7
s_lshr_b32 s10, s6, 1
s_lshl_b32 s11, s7, 3
s_add_u32 s10, s10, s11
s_lshl_b32 s10, s10, 18
s_add_u32 s20, s20, s10
s_addc_u32 s21, s21, 0
s_mov_b32 s22, 262144
s_add_u32 s24, s24, s10
s_addc_u32 s25, s25, 0
s_mov_b32 s26, 262144
s_mul_i32 s10, s6, 229376
s_add_u32 s28, s28, s10
s_addc_u32 s29, s29, 0
s_mov_b32 s30, 229376
s_mov_b32 s44, s28
s_mov_b32 s45, s29
s_cmp_eq_u32 s9, 3
s_cselect_b32 s46, 0, 229376
s_mov_b32 s47, 0x00020000
s_lshl_b32 s10, s5, 3
s_add_u32 s10, s10, s7
s_lshl_b32 s10, s10, 4
s_add_u32 s10, s10, s6
s_mul_i32 s10, s10, 57344
s_add_u32 s32, s96, s10
s_addc_u32 s33, s97, 0
s_mov_b32 s34, 57344
s_mov_b32 s35, 0x00020000
s_mov_b32 s42, 0x3db8aa3b
s_lshl_b32 s10, s5, 3
s_add_u32 s10, s10, s7
s_lshl_b32 s88, s10, 4
s_mul_i32 s11, s10, 10240
s_add_u32 s11, s11, 16777216
s_add_u32 s76, s96, s11
s_addc_u32 s77, s97, 0
s_mul_i32 s11, s10, 917504
s_add_u32 s80, s96, s11
s_addc_u32 s81, s97, 0
s_mov_b32 s82, 917504
s_mov_b32 s83, 0x00020000
s_mov_b32 s84, s36
s_mov_b32 s85, s37
s_mov_b32 s86, 917504
s_mov_b32 s87, 0x00020000
s_or_b32 s10, s6, s9
s_cmp_lg_u32 s10, 0
s_cbranch_scc1 L_no_nonce
s_memrealtime s[100:101]
v_mov_b32 v250, s88
s_waitcnt lgkmcnt(0)
s_or_b32 s100, s100, 1
v_mov_b32 v248, s100
v_mov_b32 v249, s101
s_mov_b64 exec, 1
global_store_dwordx2 v250, v[248:249], s[38:39] sc1
s_mov_b64 exec, -1
L_no_nonce:
s_branch L_firstA
L_restartA:
s_waitcnt vmcnt(0) lgkmcnt(0)
s_barrier
L_firstA:
v_subrev_u32 v80, s40, v18
v_add_u32 v80, 98304, v80
v_subrev_u32 v81, s40, v19
v_add_u32 v81, 98304, v81
v_subrev_u32 v82, s40, v20
v_add_u32 v82, 98304, v82
v_subrev_u32 v83, s40, v21
v_add_u32 v83, 98304, v83
s_add_u32 s50, s49, 0
s_sub_u32 s11, s50, 7
s_cmp_ge_u32 s50, 7
s_cselect_b32 s50, s11, s50
s_lshl_b32 s50, s50, 7
s_add_u32 m0, s48, 98304
s_add_u32 s41, s50, 0
buffer_load_dwordx4 v1, s[12:15], s41 offen lds
s_add_u32 s50, s49, 0
s_sub_u32 s11, s50, 7
s_cmp_ge_u32 s50, 7
s_cselect_b32 s50, s11, s50
s_lshl_b32 s50, s50, 7
s_add_u32 m0, s48, 102400
s_add_u32 s41, s50, 28672
buffer_load_dwordx4 v1, s[12:15], s41 offen lds
s_add_u32 s50, s49, 1
s_sub_u32 s11, s50, 7
s_cmp_ge_u32 s50, 7
s_cselect_b32 s50, s11, s50
s_lshl_b32 s50, s50, 7
s_add_u32 m0, s48, 106496
s_add_u32 s41, s50, 0
buffer_load_dwordx4 v1, s[12:15], s41 offen lds
s_add_u32 s50, s49, 1
s_sub_u32 s11, s50, 7
s_cmp_ge_u32 s50, 7
s_cselect_b32 s50, s11, s50
s_lshl_b32 s50, s50, 7
s_add_u32 m0, s48, 110592
s_add_u32 s41, s50, 28672
buffer_load_dwordx4 v1, s[12:15], s41 offen lds
s_add_u32 s50, s49, 0
s_sub_u32 s11, s50, 7
s_cmp_ge_u32 s50, 7
s_cselect_b32 s50, s11, s50
s_lshl_b32 s50, s50, 19
s_add_u32 m0, s40, 0
s_add_u32 s41, s50, 0
buffer_load_dwordx4 v2, s[16:19], s41 offen lds
buffer_load_dwordx4 v3, s[16:19], s41 offen offset:1024 lds
buffer_load_dwordx4 v4, s[16:19], s41 offen offset:2048 lds
buffer_load_dwordx4 v5, s[16:19], s41 offen offset:3072 lds
s_add_u32 s50, s49, 0
s_sub_u32 s11, s50, 7
s_cmp_ge_u32 s50, 7
s_cselect_b32 s50, s11, s50
s_lshl_b32 s50, s50, 19
s_add_u32 m0, s40, 4096
s_add_u32 s41, s50, 262144
buffer_load_dwordx4 v2, s[16:19], s41 offen lds
buffer_load_dwordx4 v3, s[16:19], s41 offen offset:1024 lds
buffer_load_dwordx4 v4, s[16:19], s41 offen offset:2048 lds
buffer_load_dwordx4 v5, s[16:19], s41 offen offset:3072 lds
s_waitcnt vmcnt(8)
s_barrier
ds_read_b128 a[0:3], v80 offset:0
ds_read_b128 a[4:7], v80 offset:4096
ds_read_b128 a[8:11], v81 offset:0
ds_read_b128 a[12:15], v81 offset:4096
s_waitcnt vmcnt(4)
ds_read_b64_tr_b16 a[32:33], v22 offset:0
ds_read_b64_tr_b16 a[34:35], v22 offset:512
ds_read_b64_tr_b16 a[36:37], v23 offset:0
ds_read_b64_tr_b16 a[38:39], v23 offset:512
ds_read_b64_tr_b16 a[40:41], v22 offset:2048
ds_read_b64_tr_b16 a[42:43], v22 offset:2560
ds_read_b64_tr_b16 a[44:45], v23 offset:2048
ds_read_b64_tr_b16 a[46:47], v23 offset:2560
s_waitcnt lgkmcnt(6)
v_mfma_f32_32x32x16_bf16 v[128:143], a[32:35], a[0:3], 0
ds_read_b128 a[16:19], v82 offset:0
ds_read_b128 a[20:23], v82 offset:4096
ds_read_b128 a[24:27], v83 offset:0
s_add_u32 s50, s49, 2
s_sub_u32 s11, s50, 7
s_cmp_ge_u32 s50, 7
s_cselect_b32 s50, s11, s50
s_lshl_b32 s50, s50, 7
s_add_u32 m0, s48, 114688
s_add_u32 s41, s50, 0
buffer_load_dwordx4 v1, s[12:15], s41 offen lds
v_mfma_f32_32x32x16_bf16 v[144:159], a[32:35], a[4:7], 0
ds_read_b128 a[28:31], v83 offset:4096
s_waitcnt vmcnt(1)
ds_read_b64_tr_b16 a[48:49], v22 offset:4096
s_add_u32 s50, s49, 2
s_sub_u32 s11, s50, 7
s_cmp_ge_u32 s50, 7
s_cselect_b32 s50, s11, s50
s_lshl_b32 s50, s50, 7
s_add_u32 m0, s48, 118784
s_add_u32 s41, s50, 28672
buffer_load_dwordx4 v1, s[12:15], s41 offen lds
s_waitcnt lgkmcnt(9)
v_mfma_f32_32x32x16_bf16 v[160:175], a[36:39], a[0:3], 0
ds_read_b64_tr_b16 a[50:51], v22 offset:4608
ds_read_b64_tr_b16 a[52:53], v23 offset:4096
ds_read_b64_tr_b16 a[54:55], v23 offset:4608
s_add_u32 s50, s49, 3
s_sub_u32 s11, s50, 7
s_cmp_ge_u32 s50, 7
s_cselect_b32 s50, s11, s50
s_lshl_b32 s50, s50, 7
s_add_u32 m0, s48, 122880
s_add_u32 s41, s50, 0
buffer_load_dwordx4 v1, s[12:15], s41 offen lds
v_mfma_f32_32x32x16_bf16 v[176:191], a[36:39], a[4:7], 0
ds_read_b64_tr_b16 a[56:57], v22 offset:6144
ds_read_b64_tr_b16 a[58:59], v22 offset:6656
ds_read_b64_tr_b16 a[60:61], v23 offset:6144
s_add_u32 s50, s49, 3
s_sub_u32 s11, s50, 7
s_cmp_ge_u32 s50, 7
s_cselect_b32 s50, s11, s50
s_lshl_b32 s50, s50, 7
s_add_u32 m0, s48, 126976
s_add_u32 s41, s50, 28672
buffer_load_dwordx4 v1, s[12:15], s41 offen lds
s_waitcnt lgkmcnt(13)
v_mfma_f32_32x32x16_bf16 v[128:143], a[40:43], a[8:11], v[128:143]
ds_read_b64_tr_b16 a[62:63], v23 offset:6656
s_add_u32 s50, s49, 4
s_sub_u32 s11, s50, 7
s_cmp_ge_u32 s50, 7
s_cselect_b32 s50, s11, s50
s_lshl_b32 s50, s50, 7
s_add_u32 m0, s48, 131072
s_add_u32 s41, s50, 0
buffer_load_dwordx4 v1, s[12:15], s41 offen lds
v_mfma_f32_32x32x16_bf16 v[144:159], a[40:43], a[12:15], v[144:159]
s_add_u32 s50, s49, 4
s_sub_u32 s11, s50, 7
s_cmp_ge_u32 s50, 7
s_cselect_b32 s50, s11, s50
s_lshl_b32 s50, s50, 7
s_add_u32 m0, s48, 135168
s_add_u32 s41, s50, 28672
buffer_load_dwordx4 v1, s[12:15], s41 offen lds
s_waitcnt lgkmcnt(12)
v_mfma_f32_32x32x16_bf16 v[160:175], a[44:47], a[8:11], v[160:175]
s_add_u32 s50, s49, 5
s_sub_u32 s11, s50, 7
s_cmp_ge_u32 s50, 7
s_cselect_b32 s50, s11, s50
s_lshl_b32 s50, s50, 7
s_add_u32 m0, s48, 139264
s_add_u32 s41, s50, 0
buffer_load_dwordx4 v1, s[12:15], s41 offen lds
v_mfma_f32_32x32x16_bf16 v[176:191], a[44:47], a[12:15], v[176:191]
s_add_u32 s50, s49, 5
s_sub_u32 s11, s50, 7
s_cmp_ge_u32 s50, 7
s_cselect_b32 s50, s11, s50
s_lshl_b32 s50, s50, 7
s_add_u32 m0, s48, 143360
s_add_u32 s41, s50, 28672
buffer_load_dwordx4 v1, s[12:15], s41 offen lds
s_waitcnt lgkmcnt(6)
v_mfma_f32_32x32x16_bf16 v[128:143], a[48:51], a[16:19], v[128:143]
ds_read_b128 a[0:3], v80 offset:8192
ds_read_b128 a[4:7], v80 offset:12288
ds_read_b128 a[8:11], v81 offset:8192
s_add_u32 s50, s49, 6
s_sub_u32 s11, s50, 7
s_cmp_ge_u32 s50, 7
s_cselect_b32 s50, s11, s50
s_lshl_b32 s50, s50, 7
s_add_u32 m0, s48, 147456
s_add_u32 s41, s50, 0
buffer_load_dwordx4 v1, s[12:15], s41 offen lds
v_mfma_f32_32x32x16_bf16 v[144:159], a[48:51], a[20:23], v[144:159]
ds_read_b128 a[12:15], v81 offset:12288
s_add_u32 s50, s49, 6
s_sub_u32 s11, s50, 7
s_cmp_ge_u32 s50, 7
s_cselect_b32 s50, s11, s50
s_lshl_b32 s50, s50, 7
s_add_u32 m0, s48, 151552
s_add_u32 s41, s50, 28672
buffer_load_dwordx4 v1, s[12:15], s41 offen lds
s_add_u32 s50, s49, 1
s_sub_u32 s11, s50, 7
s_cmp_ge_u32 s50, 7
s_cselect_b32 s50, s11, s50
s_lshl_b32 s50, s50, 19
s_add_u32 m0, s40, 8192
s_add_u32 s41, s50, 0
buffer_load_dwordx4 v2, s[16:19], s41 offen lds
buffer_load_dwordx4 v3, s[16:19], s41 offen offset:1024 lds
buffer_load_dwordx4 v4, s[16:19], s41 offen offset:2048 lds
buffer_load_dwordx4 v5, s[16:19], s41 offen offset:3072 lds
s_waitcnt vmcnt(0)
ds_read_b64_tr_b16 a[32:33], v22 offset:8192
s_add_u32 s50, s49, 1
s_sub_u32 s11, s50, 7
s_cmp_ge_u32 s50, 7
s_cselect_b32 s50, s11, s50
s_lshl_b32 s50, s50, 19
s_add_u32 m0, s40, 12288
s_add_u32 s41, s50, 262144
buffer_load_dwordx4 v2, s[16:19], s41 offen lds
s_waitcnt lgkmcnt(9)
v_mfma_f32_32x32x16_bf16 v[160:175], a[52:55], a[16:19], v[160:175]
ds_read_b64_tr_b16 a[34:35], v22 offset:8704
ds_read_b64_tr_b16 a[36:37], v23 offset:8192
ds_read_b64_tr_b16 a[38:39], v23 offset:8704
buffer_load_dwordx4 v3, s[16:19], s41 offen offset:1024 lds
v_mfma_f32_32x32x16_bf16 v[176:191], a[52:55], a[20:23], v[176:191]
ds_read_b64_tr_b16 a[40:41], v22 offset:10240
ds_read_b64_tr_b16 a[42:43], v22 offset:10752
ds_read_b64_tr_b16 a[44:45], v23 offset:10240
buffer_load_dwordx4 v4, s[16:19], s41 offen offset:2048 lds
s_waitcnt lgkmcnt(13)
v_mfma_f32_32x32x16_bf16 v[128:143], a[56:59], a[24:27], v[128:143]
ds_read_b64_tr_b16 a[46:47], v23 offset:10752
buffer_load_dwordx4 v5, s[16:19], s41 offen offset:3072 lds
v_mfma_f32_32x32x16_bf16 v[144:159], a[56:59], a[28:31], v[144:159]
s_add_u32 s50, s49, 2
s_sub_u32 s11, s50, 7
s_cmp_ge_u32 s50, 7
s_cselect_b32 s50, s11, s50
s_lshl_b32 s50, s50, 19
s_add_u32 m0, s40, 16384
s_add_u32 s41, s50, 0
buffer_load_dwordx4 v2, s[16:19], s41 offen lds
s_waitcnt lgkmcnt(12)
v_mfma_f32_32x32x16_bf16 v[160:175], a[60:63], a[24:27], v[160:175]
buffer_load_dwordx4 v3, s[16:19], s41 offen offset:1024 lds
v_mfma_f32_32x32x16_bf16 v[176:191], a[60:63], a[28:31], v[176:191]
buffer_load_dwordx4 v4, s[16:19], s41 offen offset:2048 lds
s_waitcnt lgkmcnt(6)
v_mfma_f32_32x32x16_bf16 v[128:143], a[32:35], a[0:3], v[128:143]
ds_read_b128 a[16:19], v82 offset:8192
ds_read_b128 a[20:23], v82 offset:12288
ds_read_b128 a[24:27], v83 offset:8192
buffer_load_dwordx4 v5, s[16:19], s41 offen offset:3072 lds
v_mfma_f32_32x32x16_bf16 v[144:159], a[32:35], a[4:7], v[144:159]
ds_read_b128 a[28:31], v83 offset:12288
s_waitcnt vmcnt(4)
ds_read_b64_tr_b16 a[48:49], v22 offset:12288
s_add_u32 s50, s49, 2
s_sub_u32 s11, s50, 7
s_cmp_ge_u32 s50, 7
s_cselect_b32 s50, s11, s50
s_lshl_b32 s50, s50, 19
s_add_u32 m0, s40, 20480
s_add_u32 s41, s50, 262144
buffer_load_dwordx4 v2, s[16:19], s41 offen lds
s_waitcnt lgkmcnt(9)
v_mfma_f32_32x32x16_bf16 v[160:175], a[36:39], a[0:3], v[160:175]
ds_read_b64_tr_b16 a[50:51], v22 offset:12800
ds_read_b64_tr_b16 a[52:53], v23 offset:12288
ds_read_b64_tr_b16 a[54:55], v23 offset:12800
buffer_load_dwordx4 v3, s[16:19], s41 offen offset:1024 lds
v_mfma_f32_32x32x16_bf16 v[176:191], a[36:39], a[4:7], v[176:191]
ds_read_b64_tr_b16 a[56:57], v22 offset:14336
ds_read_b64_tr_b16 a[58:59], v22 offset:14848
ds_read_b64_tr_b16 a[60:61], v23 offset:14336
buffer_load_dwordx4 v4, s[16:19], s41 offen offset:2048 lds
s_waitcnt lgkmcnt(13)
v_mfma_f32_32x32x16_bf16 v[128:143], a[40:43], a[8:11], v[128:143]
ds_read_b64_tr_b16 a[62:63], v23 offset:14848
buffer_load_dwordx4 v5, s[16:19], s41 offen offset:3072 lds
v_mfma_f32_32x32x16_bf16 v[144:159], a[40:43], a[12:15], v[144:159]
s_add_u32 s50, s49, 3
s_sub_u32 s11, s50, 7
s_cmp_ge_u32 s50, 7
s_cselect_b32 s50, s11, s50
s_lshl_b32 s50, s50, 19
s_add_u32 m0, s40, 0
s_add_u32 s41, s50, 0
buffer_load_dwordx4 v2, s[16:19], s41 offen lds
s_waitcnt lgkmcnt(12)
v_mfma_f32_32x32x16_bf16 v[160:175], a[44:47], a[8:11], v[160:175]
buffer_load_dwordx4 v3, s[16:19], s41 offen offset:1024 lds
v_mfma_f32_32x32x16_bf16 v[176:191], a[44:47], a[12:15], v[176:191]
buffer_load_dwordx4 v4, s[16:19], s41 offen offset:2048 lds
s_waitcnt vmcnt(19)
s_waitcnt lgkmcnt(0)
s_barrier
v_mfma_f32_32x32x16_bf16 v[128:143], a[48:51], a[16:19], v[128:143]
ds_read_b128 a[0:3], v80 offset:16384
ds_read_b128 a[4:7], v80 offset:20480
ds_read_b128 a[8:11], v81 offset:16384
buffer_load_dwordx4 v5, s[16:19], s41 offen offset:3072 lds
v_mfma_f32_32x32x16_bf16 v[144:159], a[48:51], a[20:23], v[144:159]
ds_read_b128 a[12:15], v81 offset:20480
s_waitcnt vmcnt(8)
ds_read_b64_tr_b16 a[32:33], v22 offset:16384
s_add_u32 s50, s49, 3
s_sub_u32 s11, s50, 7
s_cmp_ge_u32 s50, 7
s_cselect_b32 s50, s11, s50
s_lshl_b32 s50, s50, 19
s_add_u32 m0, s40, 4096
s_add_u32 s41, s50, 262144
buffer_load_dwordx4 v2, s[16:19], s41 offen lds
v_mfma_f32_32x32x16_bf16 v[160:175], a[52:55], a[16:19], v[160:175]
ds_read_b64_tr_b16 a[34:35], v22 offset:16896
ds_read_b64_tr_b16 a[36:37], v23 offset:16384
ds_read_b64_tr_b16 a[38:39], v23 offset:16896
buffer_load_dwordx4 v3, s[16:19], s41 offen offset:1024 lds
v_mfma_f32_32x32x16_bf16 v[176:191], a[52:55], a[20:23], v[176:191]
ds_read_b64_tr_b16 a[40:41], v22 offset:18432
ds_read_b64_tr_b16 a[42:43], v22 offset:18944
ds_read_b64_tr_b16 a[44:45], v23 offset:18432
buffer_load_dwordx4 v4, s[16:19], s41 offen offset:2048 lds
v_mfma_f32_32x32x16_bf16 v[128:143], a[56:59], a[24:27], v[128:143]
ds_read_b64_tr_b16 a[46:47], v23 offset:18944
buffer_load_dwordx4 v5, s[16:19], s41 offen offset:3072 lds
v_mfma_f32_32x32x16_bf16 v[144:159], a[56:59], a[28:31], v[144:159]
s_add_u32 s50, s49, 4
s_sub_u32 s11, s50, 7
s_cmp_ge_u32 s50, 7
s_cselect_b32 s50, s11, s50
s_lshl_b32 s50, s50, 19
s_add_u32 m0, s40, 8192
s_add_u32 s41, s50, 0
buffer_load_dwordx4 v2, s[16:19], s41 offen lds
v_mfma_f32_32x32x16_bf16 v[160:175], a[60:63], a[24:27], v[160:175]
buffer_load_dwordx4 v3, s[16:19], s41 offen offset:1024 lds
v_mfma_f32_32x32x16_bf16 v[176:191], a[60:63], a[28:31], v[176:191]
buffer_load_dwordx4 v4, s[16:19], s41 offen offset:2048 lds
s_waitcnt lgkmcnt(6)
v_mfma_f32_32x32x16_bf16 v[128:143], a[32:35], a[0:3], v[128:143]
ds_read_b128 a[16:19], v82 offset:16384
ds_read_b128 a[20:23], v82 offset:20480
ds_read_b128 a[24:27], v83 offset:16384
buffer_load_dwordx4 v5, s[16:19], s41 offen offset:3072 lds
v_mfma_f32_32x32x16_bf16 v[144:159], a[32:35], a[4:7], v[144:159]
ds_read_b128 a[28:31], v83 offset:20480
s_waitcnt vmcnt(12)
ds_read_b64_tr_b16 a[48:49], v22 offset:20480
s_add_u32 s50, s49, 4
s_sub_u32 s11, s50, 7
s_cmp_ge_u32 s50, 7
s_cselect_b32 s50, s11, s50
s_lshl_b32 s50, s50, 19
s_add_u32 m0, s40, 12288
s_add_u32 s41, s50, 262144
buffer_load_dwordx4 v2, s[16:19], s41 offen lds
s_waitcnt lgkmcnt(9)
v_mfma_f32_32x32x16_bf16 v[160:175], a[36:39], a[0:3], v[160:175]
ds_read_b64_tr_b16 a[50:51], v22 offset:20992
ds_read_b64_tr_b16 a[52:53], v23 offset:20480
ds_read_b64_tr_b16 a[54:55], v23 offset:20992
buffer_load_dwordx4 v3, s[16:19], s41 offen offset:1024 lds
v_mfma_f32_32x32x16_bf16 v[176:191], a[36:39], a[4:7], v[176:191]
ds_read_b64_tr_b16 a[56:57], v22 offset:22528
ds_read_b64_tr_b16 a[58:59], v22 offset:23040
ds_read_b64_tr_b16 a[60:61], v23 offset:22528
buffer_load_dwordx4 v4, s[16:19], s41 offen offset:2048 lds
s_waitcnt lgkmcnt(13)
v_mfma_f32_32x32x16_bf16 v[128:143], a[40:43], a[8:11], v[128:143]
ds_read_b64_tr_b16 a[62:63], v23 offset:23040
buffer_load_dwordx4 v5, s[16:19], s41 offen offset:3072 lds
v_mfma_f32_32x32x16_bf16 v[144:159], a[40:43], a[12:15], v[144:159]
s_add_u32 s50, s49, 5
s_sub_u32 s11, s50, 7
s_cmp_ge_u32 s50, 7
s_cselect_b32 s50, s11, s50
s_lshl_b32 s50, s50, 19
s_add_u32 m0, s40, 16384
s_add_u32 s41, s50, 0
s_waitcnt lgkmcnt(12)
buffer_load_dwordx4 v2, s[16:19], s41 offen lds
v_mfma_f32_32x32x16_bf16 v[160:175], a[44:47], a[8:11], v[160:175]
buffer_load_dwordx4 v3, s[16:19], s41 offen offset:1024 lds
v_mfma_f32_32x32x16_bf16 v[176:191], a[44:47], a[12:15], v[176:191]
buffer_load_dwordx4 v4, s[16:19], s41 offen offset:2048 lds
s_waitcnt lgkmcnt(6)
v_mfma_f32_32x32x16_bf16 v[128:143], a[48:51], a[16:19], v[128:143]
ds_read_b128 a[0:3], v80 offset:24576
ds_read_b128 a[4:7], v80 offset:28672
ds_read_b128 a[8:11], v81 offset:24576
buffer_load_dwordx4 v5, s[16:19], s41 offen offset:3072 lds
v_mfma_f32_32x32x16_bf16 v[144:159], a[48:51], a[20:23], v[144:159]
ds_read_b128 a[12:15], v81 offset:28672
s_waitcnt vmcnt(16)
ds_read_b64_tr_b16 a[32:33], v22 offset:0
s_waitcnt lgkmcnt(9)
v_mfma_f32_32x32x16_bf16 v[160:175], a[52:55], a[16:19], v[160:175]
ds_read_b64_tr_b16 a[34:35], v22 offset:512
ds_read_b64_tr_b16 a[36:37], v23 offset:0
ds_read_b64_tr_b16 a[38:39], v23 offset:512
s_add_u32 s50, s49, 5
s_sub_u32 s11, s50, 7
s_cmp_ge_u32 s50, 7
s_cselect_b32 s50, s11, s50
s_lshl_b32 s50, s50, 19
s_add_u32 m0, s40, 20480
s_add_u32 s41, s50, 262144
s_waitcnt lgkmcnt(8)
buffer_load_dwordx4 v2, s[16:19], s41 offen lds
v_mfma_f32_32x32x16_bf16 v[176:191], a[52:55], a[20:23], v[176:191]
ds_read_b64_tr_b16 a[40:41], v22 offset:2048
ds_read_b64_tr_b16 a[42:43], v22 offset:2560
ds_read_b64_tr_b16 a[44:45], v23 offset:2048
v_mfma_f32_32x32x16_bf16 v[128:143], a[56:59], a[24:27], v[128:143]
ds_read_b64_tr_b16 a[46:47], v23 offset:2560
buffer_load_dwordx4 v3, s[16:19], s41 offen offset:1024 lds
v_mfma_f32_32x32x16_bf16 v[144:159], a[56:59], a[28:31], v[144:159]
v_mfma_f32_32x32x16_bf16 v[160:175], a[60:63], a[24:27], v[160:175]
buffer_load_dwordx4 v4, s[16:19], s41 offen offset:2048 lds
v_mfma_f32_32x32x16_bf16 v[176:191], a[60:63], a[28:31], v[176:191]
s_waitcnt lgkmcnt(6)
v_mfma_f32_32x32x16_bf16 v[128:143], a[32:35], a[0:3], v[128:143]
ds_read_b128 a[16:19], v82 offset:24576
ds_read_b128 a[20:23], v82 offset:28672
ds_read_b128 a[24:27], v83 offset:24576
buffer_load_dwordx4 v5, s[16:19], s41 offen offset:3072 lds
v_mfma_f32_32x32x16_bf16 v[144:159], a[32:35], a[4:7], v[144:159]
ds_read_b128 a[28:31], v83 offset:28672
s_waitcnt vmcnt(16)
ds_read_b64_tr_b16 a[48:49], v22 offset:4096
s_waitcnt lgkmcnt(9)
v_mfma_f32_32x32x16_bf16 v[160:175], a[36:39], a[0:3], v[160:175]
ds_read_b64_tr_b16 a[50:51], v22 offset:4608
ds_read_b64_tr_b16 a[52:53], v23 offset:4096
ds_read_b64_tr_b16 a[54:55], v23 offset:4608
s_add_u32 s50, s49, 6
s_sub_u32 s11, s50, 7
s_cmp_ge_u32 s50, 7
s_cselect_b32 s50, s11, s50
s_lshl_b32 s50, s50, 19
s_add_u32 m0, s40, 0
s_add_u32 s41, s50, 0
s_waitcnt lgkmcnt(8)
buffer_load_dwordx4 v2, s[16:19], s41 offen lds
v_mfma_f32_32x32x16_bf16 v[176:191], a[36:39], a[4:7], v[176:191]
ds_read_b64_tr_b16 a[56:57], v22 offset:6144
ds_read_b64_tr_b16 a[58:59], v22 offset:6656
ds_read_b64_tr_b16 a[60:61], v23 offset:6144
v_mfma_f32_32x32x16_bf16 v[128:143], a[40:43], a[8:11], v[128:143]
ds_read_b64_tr_b16 a[62:63], v23 offset:6656
buffer_load_dwordx4 v3, s[16:19], s41 offen offset:1024 lds
v_mfma_f32_32x32x16_bf16 v[144:159], a[40:43], a[12:15], v[144:159]
v_mfma_f32_32x32x16_bf16 v[160:175], a[44:47], a[8:11], v[160:175]
buffer_load_dwordx4 v4, s[16:19], s41 offen offset:2048 lds
v_mfma_f32_32x32x16_bf16 v[176:191], a[44:47], a[12:15], v[176:191]
s_waitcnt lgkmcnt(6)
v_mfma_f32_32x32x16_bf16 v[128:143], a[48:51], a[16:19], v[128:143]
ds_read_b128 a[0:3], v80 offset:32768
ds_read_b128 a[4:7], v80 offset:36864
ds_read_b128 a[8:11], v81 offset:32768
buffer_load_dwordx4 v5, s[16:19], s41 offen offset:3072 lds
v_mfma_f32_32x32x16_bf16 v[144:159], a[48:51], a[20:23], v[144:159]
ds_read_b128 a[12:15], v81 offset:36864
s_waitcnt vmcnt(16)
ds_read_b64_tr_b16 a[32:33], v22 offset:8192
s_waitcnt lgkmcnt(9)
v_mfma_f32_32x32x16_bf16 v[160:175], a[52:55], a[16:19], v[160:175]
ds_read_b64_tr_b16 a[34:35], v22 offset:8704
ds_read_b64_tr_b16 a[36:37], v23 offset:8192
ds_read_b64_tr_b16 a[38:39], v23 offset:8704
s_add_u32 s50, s49, 6
s_sub_u32 s11, s50, 7
s_cmp_ge_u32 s50, 7
s_cselect_b32 s50, s11, s50
s_lshl_b32 s50, s50, 19
s_add_u32 m0, s40, 4096
s_add_u32 s41, s50, 262144
s_waitcnt lgkmcnt(8)
buffer_load_dwordx4 v2, s[16:19], s41 offen lds
v_mfma_f32_32x32x16_bf16 v[176:191], a[52:55], a[20:23], v[176:191]
ds_read_b64_tr_b16 a[40:41], v22 offset:10240
ds_read_b64_tr_b16 a[42:43], v22 offset:10752
ds_read_b64_tr_b16 a[44:45], v23 offset:10240
v_mfma_f32_32x32x16_bf16 v[128:143], a[56:59], a[24:27], v[128:143]
ds_read_b64_tr_b16 a[46:47], v23 offset:10752
buffer_load_dwordx4 v3, s[16:19], s41 offen offset:1024 lds
v_mfma_f32_32x32x16_bf16 v[144:159], a[56:59], a[28:31], v[144:159]
v_mfma_f32_32x32x16_bf16 v[160:175], a[60:63], a[24:27], v[160:175]
buffer_load_dwordx4 v4, s[16:19], s41 offen offset:2048 lds
v_mfma_f32_32x32x16_bf16 v[176:191], a[60:63], a[28:31], v[176:191]
s_waitcnt lgkmcnt(6)
v_mfma_f32_32x32x16_bf16 v[128:143], a[32:35], a[0:3], v[128:143]
ds_read_b128 a[16:19], v82 offset:32768
ds_read_b128 a[20:23], v82 offset:36864
ds_read_b128 a[24:27], v83 offset:32768
buffer_load_dwordx4 v5, s[16:19], s41 offen offset:3072 lds
v_mfma_f32_32x32x16_bf16 v[144:159], a[32:35], a[4:7], v[144:159]
ds_read_b128 a[28:31], v83 offset:36864
s_waitcnt vmcnt(16)
ds_read_b64_tr_b16 a[48:49], v22 offset:12288
s_waitcnt lgkmcnt(9)
v_mfma_f32_32x32x16_bf16 v[160:175], a[36:39], a[0:3], v[160:175]
ds_read_b64_tr_b16 a[50:51], v22 offset:12800
ds_read_b64_tr_b16 a[52:53], v23 offset:12288
ds_read_b64_tr_b16 a[54:55], v23 offset:12800
s_add_u32 m0, s40, 8192
s_mov_b32 s41, 0
s_waitcnt lgkmcnt(8)
buffer_load_dwordx4 v6, s[20:23], s41 offen lds
v_mfma_f32_32x32x16_bf16 v[176:191], a[36:39], a[4:7], v[176:191]
ds_read_b64_tr_b16 a[56:57], v22 offset:14336
ds_read_b64_tr_b16 a[58:59], v22 offset:14848
ds_read_b64_tr_b16 a[60:61], v23 offset:14336
v_mfma_f32_32x32x16_bf16 v[128:143], a[40:43], a[8:11], v[128:143]
ds_read_b64_tr_b16 a[62:63], v23 offset:14848
buffer_load_dwordx4 v7, s[20:23], s41 offen offset:1024 lds
v_mfma_f32_32x32x16_bf16 v[144:159], a[40:43], a[12:15], v[144:159]
v_mfma_f32_32x32x16_bf16 v[160:175], a[44:47], a[8:11], v[160:175]
buffer_load_dwordx4 v8, s[20:23], s41 offen offset:2048 lds
v_mfma_f32_32x32x16_bf16 v[176:191], a[44:47], a[12:15], v[176:191]
s_waitcnt lgkmcnt(6)
v_mfma_f32_32x32x16_bf16 v[128:143], a[48:51], a[16:19], v[128:143]
ds_read_b128 a[0:3], v80 offset:40960
ds_read_b128 a[4:7], v80 offset:45056
ds_read_b128 a[8:11], v81 offset:40960
buffer_load_dwordx4 v9, s[20:23], s41 offen offset:3072 lds
v_mfma_f32_32x32x16_bf16 v[144:159], a[48:51], a[20:23], v[144:159]
ds_read_b128 a[12:15], v81 offset:45056
s_waitcnt vmcnt(16)
ds_read_b64_tr_b16 a[32:33], v22 offset:16384
s_waitcnt lgkmcnt(9)
v_mfma_f32_32x32x16_bf16 v[160:175], a[52:55], a[16:19], v[160:175]
ds_read_b64_tr_b16 a[34:35], v22 offset:16896
ds_read_b64_tr_b16 a[36:37], v23 offset:16384
ds_read_b64_tr_b16 a[38:39], v23 offset:16896
s_add_u32 m0, s40, 12288
s_mov_b32 s41, 128
s_waitcnt lgkmcnt(8)
buffer_load_dwordx4 v6, s[20:23], s41 offen lds
v_mfma_f32_32x32x16_bf16 v[176:191], a[52:55], a[20:23], v[176:191]
ds_read_b64_tr_b16 a[40:41], v22 offset:18432
ds_read_b64_tr_b16 a[42:43], v22 offset:18944
ds_read_b64_tr_b16 a[44:45], v23 offset:18432
v_mfma_f32_32x32x16_bf16 v[128:143], a[56:59], a[24:27], v[128:143]
ds_read_b64_tr_b16 a[46:47], v23 offset:18944
buffer_load_dwordx4 v7, s[20:23], s41 offen offset:1024 lds
v_mfma_f32_32x32x16_bf16 v[144:159], a[56:59], a[28:31], v[144:159]
v_mfma_f32_32x32x16_bf16 v[160:175], a[60:63], a[24:27], v[160:175]
buffer_load_dwordx4 v8, s[20:23], s41 offen offset:2048 lds
v_mfma_f32_32x32x16_bf16 v[176:191], a[60:63], a[28:31], v[176:191]
s_waitcnt lgkmcnt(0)
s_barrier
v_mfma_f32_32x32x16_bf16 v[128:143], a[32:35], a[0:3], v[128:143]
ds_read_b128 a[16:19], v82 offset:40960
ds_read_b128 a[20:23], v82 offset:45056
ds_read_b128 a[24:27], v83 offset:40960
buffer_load_dwordx4 v9, s[20:23], s41 offen offset:3072 lds
v_mfma_f32_32x32x16_bf16 v[144:159], a[32:35], a[4:7], v[144:159]
ds_read_b128 a[28:31], v83 offset:45056
s_waitcnt vmcnt(16)
ds_read_b64_tr_b16 a[48:49], v22 offset:20480
v_mfma_f32_32x32x16_bf16 v[160:175], a[36:39], a[0:3], v[160:175]
ds_read_b64_tr_b16 a[50:51], v22 offset:20992
ds_read_b64_tr_b16 a[52:53], v23 offset:20480
ds_read_b64_tr_b16 a[54:55], v23 offset:20992
s_add_u32 m0, s40, 16384
s_mov_b32 s41, 256
buffer_load_dwordx4 v6, s[20:23], s41 offen lds
v_mfma_f32_32x32x16_bf16 v[176:191], a[36:39], a[4:7], v[176:191]
ds_read_b64_tr_b16 a[56:57], v22 offset:22528
ds_read_b64_tr_b16 a[58:59], v22 offset:23040
ds_read_b64_tr_b16 a[60:61], v23 offset:22528
v_mfma_f32_32x32x16_bf16 v[128:143], a[40:43], a[8:11], v[128:143]
ds_read_b64_tr_b16 a[62:63], v23 offset:23040
buffer_load_dwordx4 v7, s[20:23], s41 offen offset:1024 lds
v_mfma_f32_32x32x16_bf16 v[144:159], a[40:43], a[12:15], v[144:159]
v_mfma_f32_32x32x16_bf16 v[160:175], a[44:47], a[8:11], v[160:175]
buffer_load_dwordx4 v8, s[20:23], s41 offen offset:2048 lds
v_mfma_f32_32x32x16_bf16 v[176:191], a[44:47], a[12:15], v[176:191]
s_waitcnt lgkmcnt(6)
v_mfma_f32_32x32x16_bf16 v[128:143], a[48:51], a[16:19], v[128:143]
ds_read_b128 a[0:3], v80 offset:49152
ds_read_b128 a[4:7], v80 offset:53248
ds_read_b128 a[8:11], v81 offset:49152
buffer_load_dwordx4 v9, s[20:23], s41 offen offset:3072 lds
v_mfma_f32_32x32x16_bf16 v[144:159], a[48:51], a[20:23], v[144:159]
ds_read_b128 a[12:15], v81 offset:53248
s_waitcnt vmcnt(16)
ds_read_b64_tr_b16 a[32:33], v22 offset:0
s_waitcnt lgkmcnt(9)
v_mfma_f32_32x32x16_bf16 v[160:175], a[52:55], a[16:19], v[160:175]
ds_read_b64_tr_b16 a[34:35], v22 offset:512
ds_read_b64_tr_b16 a[36:37], v23 offset:0
ds_read_b64_tr_b16 a[38:39], v23 offset:512
s_add_u32 m0, s40, 20480
s_mov_b32 s41, 384
s_waitcnt lgkmcnt(8)
buffer_load_dwordx4 v6, s[20:23], s41 offen lds
v_mfma_f32_32x32x16_bf16 v[176:191], a[52:55], a[20:23], v[176:191]
ds_read_b64_tr_b16 a[40:41], v22 offset:2048
ds_read_b64_tr_b16 a[42:43], v22 offset:2560
ds_read_b64_tr_b16 a[44:45], v23 offset:2048
v_mfma_f32_32x32x16_bf16 v[128:143], a[56:59], a[24:27], v[128:143]
ds_read_b64_tr_b16 a[46:47], v23 offset:2560
buffer_load_dwordx4 v7, s[20:23], s41 offen offset:1024 lds
v_mfma_f32_32x32x16_bf16 v[144:159], a[56:59], a[28:31], v[144:159]
v_mfma_f32_32x32x16_bf16 v[160:175], a[60:63], a[24:27], v[160:175]
buffer_load_dwordx4 v8, s[20:23], s41 offen offset:2048 lds
v_mfma_f32_32x32x16_bf16 v[176:191], a[60:63], a[28:31], v[176:191]
s_waitcnt lgkmcnt(6)
v_mfma_f32_32x32x16_bf16 v[128:143], a[32:35], a[0:3], v[128:143]
ds_read_b128 a[16:19], v82 offset:49152
ds_read_b128 a[20:23], v82 offset:53248
ds_read_b128 a[24:27], v83 offset:49152
buffer_load_dwordx4 v9, s[20:23], s41 offen offset:3072 lds
v_mfma_f32_32x32x16_bf16 v[144:159], a[32:35], a[4:7], v[144:159]
ds_read_b128 a[28:31], v83 offset:53248
s_waitcnt vmcnt(16)
ds_read_b64_tr_b16 v[192:193], v22 offset:4096
s_waitcnt lgkmcnt(9)
v_mfma_f32_32x32x16_bf16 v[160:175], a[36:39], a[0:3], v[160:175]
ds_read_b64_tr_b16 v[194:195], v22 offset:4608
ds_read_b64_tr_b16 v[196:197], v23 offset:4096
ds_read_b64_tr_b16 v[198:199], v23 offset:4608
s_add_u32 m0, s40, 0
s_mov_b32 s41, 16384
s_waitcnt lgkmcnt(8)
buffer_load_dwordx4 v6, s[20:23], s41 offen lds
v_mfma_f32_32x32x16_bf16 v[176:191], a[36:39], a[4:7], v[176:191]
ds_read_b64_tr_b16 v[200:201], v22 offset:6144
ds_read_b64_tr_b16 v[202:203], v22 offset:6656
ds_read_b64_tr_b16 v[204:205], v23 offset:6144
v_mfma_f32_32x32x16_bf16 v[128:143], a[40:43], a[8:11], v[128:143]
ds_read_b64_tr_b16 v[206:207], v23 offset:6656
buffer_load_dwordx4 v7, s[20:23], s41 offen offset:1024 lds
v_mfma_f32_32x32x16_bf16 v[144:159], a[40:43], a[12:15], v[144:159]
v_mfma_f32_32x32x16_bf16 v[160:175], a[44:47], a[8:11], v[160:175]
buffer_load_dwordx4 v8, s[20:23], s41 offen offset:2048 lds
v_mfma_f32_32x32x16_bf16 v[176:191], a[44:47], a[12:15], v[176:191]
s_waitcnt lgkmcnt(6)
v_mfma_f32_32x32x16_bf16 v[128:143], v[192:195], a[16:19], v[128:143]
s_waitcnt vmcnt(15)
ds_read_b128 v[208:211], v18 offset:8192
ds_read_b128 v[212:215], v19 offset:8192
buffer_load_dwordx4 v9, s[20:23], s41 offen offset:3072 lds
s_waitcnt lgkmcnt(4)
v_mfma_f32_32x32x16_bf16 v[128:143], v[200:203], a[24:27], v[128:143]
ds_read_b128 v[216:219], v20 offset:8192
ds_read_b128 v[220:223], v21 offset:8192
v_mfma_f32_32x32x16_bf16 v[144:159], v[192:195], a[20:23], v[144:159]
s_add_u32 m0, s40, 4096
s_mov_b32 s41, 16512
s_waitcnt lgkmcnt(4)
buffer_load_dwordx4 v6, s[20:23], s41 offen lds
v_mfma_f32_32x32x16_bf16 v[144:159], v[200:203], a[28:31], v[144:159]
v_mfma_f32_32x32x16_bf16 v[160:175], v[196:199], a[16:19], v[160:175]
buffer_load_dwordx4 v7, s[20:23], s41 offen offset:1024 lds
s_nop 1
v_mul_f32 v128, s42, v128
v_mul_f32 v129, s42, v129
v_mul_f32 v130, s42, v130
v_mul_f32 v131, s42, v131
v_mul_f32 v132, s42, v132
v_mul_f32 v133, s42, v133
v_mfma_f32_32x32x16_bf16 v[160:175], v[204:207], a[24:27], v[160:175]
v_mul_f32 v134, s42, v134
v_mul_f32 v135, s42, v135
v_cvt_pk_bf16_f32 v80, v128, v129
v_cvt_pk_bf16_f32 v81, v130, v131
v_cvt_pk_bf16_f32 v82, v132, v133
v_cvt_pk_bf16_f32 v83, v134, v135
v_mfma_f32_32x32x16_bf16 v[176:191], v[196:199], a[20:23], v[176:191]
buffer_load_dwordx4 v8, s[20:23], s41 offen offset:2048 lds
ds_write_b128 v29, v[80:83] offset:0
v_mul_f32 v136, s42, v136
v_mul_f32 v137, s42, v137
v_mul_f32 v138, s42, v138
v_mul_f32 v139, s42, v139
v_mul_f32 v140, s42, v140
v_mfma_f32_32x32x16_bf16 v[176:191], v[204:207], a[28:31], v[176:191]
v_mul_f32 v141, s42, v141
v_mul_f32 v142, s42, v142
v_mul_f32 v143, s42, v143
v_cvt_pk_bf16_f32 v84, v136, v137
v_cvt_pk_bf16_f32 v85, v138, v139
v_cvt_pk_bf16_f32 v86, v140, v141
v_cvt_pk_bf16_f32 v87, v142, v143
ds_write_b128 v29, v[84:87] offset:2048
v_mul_f32 v144, s42, v144
v_mul_f32 v145, s42, v145
v_mul_f32 v146, s42, v146
v_mul_f32 v147, s42, v147
v_mul_f32 v148, s42, v148
v_mul_f32 v149, s42, v149
v_mul_f32 v150, s42, v150
v_mul_f32 v151, s42, v151
v_cvt_pk_bf16_f32 v88, v144, v145
v_cvt_pk_bf16_f32 v89, v146, v147
v_cvt_pk_bf16_f32 v90, v148, v149
v_cvt_pk_bf16_f32 v91, v150, v151
ds_write_b128 v29, v[88:91] offset:1024
v_mul_f32 v152, s42, v152
v_mul_f32 v153, s42, v153
v_mul_f32 v154, s42, v154
v_mul_f32 v155, s42, v155
v_mul_f32 v156, s42, v156
v_mul_f32 v157, s42, v157
v_mul_f32 v158, s42, v158
v_mul_f32 v159, s42, v159
v_cvt_pk_bf16_f32 v92, v152, v153
buffer_load_dwordx4 v9, s[20:23], s41 offen offset:3072 lds
v_cvt_pk_bf16_f32 v93, v154, v155
v_cvt_pk_bf16_f32 v94, v156, v157
v_cvt_pk_bf16_f32 v95, v158, v159
ds_write_b128 v29, v[92:95] offset:3072
v_mul_f32 v160, s42, v160
v_mul_f32 v161, s42, v161
v_mul_f32 v162, s42, v162
v_mul_f32 v163, s42, v163
v_mul_f32 v164, s42, v164
v_mul_f32 v165, s42, v165
v_mul_f32 v166, s42, v166
v_mul_f32 v167, s42, v167
v_cvt_pk_bf16_f32 v80, v160, v161
v_cvt_pk_bf16_f32 v81, v162, v163
v_cvt_pk_bf16_f32 v82, v164, v165
v_cvt_pk_bf16_f32 v83, v166, v167
ds_write_b128 v29, v[80:83] offset:4096
v_mul_f32 v168, s42, v168
v_mul_f32 v169, s42, v169
v_mul_f32 v170, s42, v170
v_mul_f32 v171, s42, v171
v_mul_f32 v172, s42, v172
v_mul_f32 v173, s42, v173
v_mul_f32 v174, s42, v174
s_add_u32 m0, s40, 8192
s_mov_b32 s41, 16640
s_waitcnt lgkmcnt(5)
buffer_load_dwordx4 v6, s[20:23], s41 offen lds
v_mul_f32 v175, s42, v175
v_cvt_pk_bf16_f32 v84, v168, v169
v_cvt_pk_bf16_f32 v85, v170, v171
v_cvt_pk_bf16_f32 v86, v172, v173
v_cvt_pk_bf16_f32 v87, v174, v175
ds_write_b128 v29, v[84:87] offset:6144
v_mul_f32 v176, s42, v176
v_mul_f32 v177, s42, v177
v_mul_f32 v178, s42, v178
v_mul_f32 v179, s42, v179
v_mul_f32 v180, s42, v180
v_mul_f32 v181, s42, v181
v_mul_f32 v182, s42, v182
v_mul_f32 v183, s42, v183
v_cvt_pk_bf16_f32 v88, v176, v177
v_cvt_pk_bf16_f32 v89, v178, v179
v_cvt_pk_bf16_f32 v90, v180, v181
v_cvt_pk_bf16_f32 v91, v182, v183
ds_write_b128 v29, v[88:91] offset:5120
v_mul_f32 v184, s42, v184
v_mul_f32 v185, s42, v185
v_mul_f32 v186, s42, v186
v_mul_f32 v187, s42, v187
v_mul_f32 v188, s42, v188
buffer_load_dwordx4 v7, s[20:23], s41 offen offset:1024 lds
v_mul_f32 v189, s42, v189
v_mul_f32 v190, s42, v190
v_mul_f32 v191, s42, v191
v_cvt_pk_bf16_f32 v92, v184, v185
v_cvt_pk_bf16_f32 v93, v186, v187
v_cvt_pk_bf16_f32 v94, v188, v189
v_cvt_pk_bf16_f32 v95, v190, v191
ds_write_b128 v29, v[92:95] offset:7168
s_waitcnt lgkmcnt(0)
s_barrier
ds_read_b128 a[0:3], v28 offset:0
ds_read_b128 a[4:7], v28 offset:1024
ds_read_b128 a[8:11], v28 offset:2048
ds_read_b128 a[12:15], v28 offset:3072
ds_read_b128 a[16:19], v28 offset:4096
ds_read_b128 a[20:23], v28 offset:5120
ds_read_b128 a[24:27], v28 offset:6144
ds_read_b128 a[28:31], v28 offset:7168
s_waitcnt lgkmcnt(7)
v_mfma_f32_32x32x16_bf16 v[128:143], v[208:211], a[0:3], v[96:111]
ds_read_b128 a[32:35], v28 offset:8192
ds_read_b128 a[36:39], v28 offset:9216
ds_read_b128 a[40:43], v28 offset:10240
s_waitcnt lgkmcnt(9)
v_mfma_f32_32x32x16_bf16 v[144:159], v[208:211], a[4:7], v[112:127]
ds_read_b128 a[44:47], v28 offset:11264
ds_read_b128 a[48:51], v28 offset:12288
ds_read_b128 a[52:55], v28 offset:13312
s_waitcnt lgkmcnt(11)
v_mfma_f32_32x32x16_bf16 v[128:143], v[212:215], a[8:11], v[128:143]
ds_read_b128 a[56:59], v28 offset:14336
ds_read_b128 a[60:63], v28 offset:15360
s_waitcnt vmcnt(18)
s_waitcnt lgkmcnt(12)
v_mfma_f32_32x32x16_bf16 v[144:159], v[212:215], a[12:15], v[144:159]
ds_read_b128 v[192:195], v18 offset:12288
ds_read_b128 v[196:199], v19 offset:12288
ds_read_b128 v[200:203], v20 offset:12288
buffer_load_dwordx4 v8, s[20:23], s41 offen offset:2048 lds
s_waitcnt lgkmcnt(14)
v_mfma_f32_32x32x16_bf16 v[128:143], v[216:219], a[16:19], v[128:143]
ds_read_b128 v[204:207], v21 offset:12288
buffer_load_dwordx4 v9, s[20:23], s41 offen offset:3072 lds
s_waitcnt lgkmcnt(14)
v_mfma_f32_32x32x16_bf16 v[144:159], v[216:219], a[20:23], v[144:159]
s_waitcnt lgkmcnt(13)
v_mfma_f32_32x32x16_bf16 v[128:143], v[220:223], a[24:27], v[128:143]
s_add_u32 m0, s40, 12288
s_mov_b32 s41, 16768
s_waitcnt lgkmcnt(0)
buffer_load_dwordx4 v6, s[20:23], s41 offen lds
v_mfma_f32_32x32x16_bf16 v[144:159], v[220:223], a[28:31], v[144:159]
buffer_load_dwordx4 v7, s[20:23], s41 offen offset:1024 lds
v_mfma_f32_32x32x16_bf16 v[128:143], v[192:195], a[32:35], v[128:143]
ds_read_b128 a[64:67], v28 offset:16384
ds_read_b128 a[68:71], v28 offset:17408
ds_read_b128 a[72:75], v28 offset:18432
buffer_load_dwordx4 v8, s[20:23], s41 offen offset:2048 lds
v_mfma_f32_32x32x16_bf16 v[144:159], v[192:195], a[36:39], v[144:159]
ds_read_b128 a[76:79], v28 offset:19456
ds_read_b128 a[80:83], v28 offset:20480
ds_read_b128 a[84:87], v28 offset:21504
buffer_load_dwordx4 v9, s[20:23], s41 offen offset:3072 lds
v_mfma_f32_32x32x16_bf16 v[128:143], v[196:199], a[40:43], v[128:143]
ds_read_b128 a[88:91], v28 offset:22528
ds_read_b128 a[92:95], v28 offset:23552
s_waitcnt vmcnt(20)
v_mfma_f32_32x32x16_bf16 v[144:159], v[196:199], a[44:47], v[144:159]
ds_read_b128 v[208:211], v18 offset:16384
ds_read_b128 v[212:215], v19 offset:16384
ds_read_b128 v[216:219], v20 offset:16384
v_mfma_f32_32x32x16_bf16 v[128:143], v[200:203], a[48:51], v[128:143]
ds_read_b128 v[220:223], v21 offset:16384
v_mfma_f32_32x32x16_bf16 v[144:159], v[200:203], a[52:55], v[144:159]
v_mfma_f32_32x32x16_bf16 v[128:143], v[204:207], a[56:59], v[128:143]
s_add_u32 m0, s40, 16384
s_mov_b32 s41, 32768
s_waitcnt lgkmcnt(0)
buffer_load_dwordx4 v6, s[20:23], s41 offen lds
v_mfma_f32_32x32x16_bf16 v[144:159], v[204:207], a[60:63], v[144:159]
buffer_load_dwordx4 v7, s[20:23], s41 offen offset:1024 lds
v_mfma_f32_32x32x16_bf16 v[128:143], v[208:211], a[64:67], v[128:143]
ds_read_b128 a[96:99], v28 offset:24576
ds_read_b128 a[100:103], v28 offset:25600
ds_read_b128 a[104:107], v28 offset:26624
buffer_load_dwordx4 v8, s[20:23], s41 offen offset:2048 lds
v_mfma_f32_32x32x16_bf16 v[144:159], v[208:211], a[68:71], v[144:159]
ds_read_b128 a[108:111], v28 offset:27648
ds_read_b128 a[112:115], v28 offset:28672
ds_read_b128 a[116:119], v28 offset:29696
buffer_load_dwordx4 v9, s[20:23], s41 offen offset:3072 lds
v_mfma_f32_32x32x16_bf16 v[128:143], v[212:215], a[72:75], v[128:143]
ds_read_b128 a[120:123], v28 offset:30720
ds_read_b128 a[124:127], v28 offset:31744
s_waitcnt vmcnt(20)
v_mfma_f32_32x32x16_bf16 v[144:159], v[212:215], a[76:79], v[144:159]
ds_read_b128 v[192:195], v18 offset:20480
ds_read_b128 v[196:199], v19 offset:20480
ds_read_b128 v[200:203], v20 offset:20480
v_mfma_f32_32x32x16_bf16 v[128:143], v[216:219], a[80:83], v[128:143]
ds_read_b128 v[204:207], v21 offset:20480
v_mfma_f32_32x32x16_bf16 v[144:159], v[216:219], a[84:87], v[144:159]
v_mfma_f32_32x32x16_bf16 v[128:143], v[220:223], a[88:91], v[128:143]
s_add_u32 m0, s40, 20480
s_mov_b32 s41, 32896
s_waitcnt lgkmcnt(0)
buffer_load_dwordx4 v6, s[20:23], s41 offen lds
v_mfma_f32_32x32x16_bf16 v[144:159], v[220:223], a[92:95], v[144:159]
buffer_load_dwordx4 v7, s[20:23], s41 offen offset:1024 lds
v_mfma_f32_32x32x16_bf16 v[128:143], v[192:195], a[96:99], v[128:143]
s_waitcnt vmcnt(18)
ds_read_b128 v[208:211], v18 offset:0
ds_read_b128 v[212:215], v19 offset:0
buffer_load_dwordx4 v8, s[20:23], s41 offen offset:2048 lds
v_mfma_f32_32x32x16_bf16 v[144:159], v[192:195], a[100:103], v[144:159]
ds_read_b128 v[216:219], v20 offset:0
ds_read_b128 v[220:223], v21 offset:0
buffer_load_dwordx4 v9, s[20:23], s41 offen offset:3072 lds
v_mfma_f32_32x32x16_bf16 v[128:143], v[196:199], a[104:107], v[128:143]
v_mfma_f32_32x32x16_bf16 v[144:159], v[196:199], a[108:111], v[144:159]
s_add_u32 m0, s40, 0
s_mov_b32 s41, 33024
s_waitcnt lgkmcnt(0)
buffer_load_dwordx4 v6, s[20:23], s41 offen lds
v_mfma_f32_32x32x16_bf16 v[128:143], v[200:203], a[112:115], v[128:143]
buffer_load_dwordx4 v7, s[20:23], s41 offen offset:1024 lds
v_mfma_f32_32x32x16_bf16 v[144:159], v[200:203], a[116:119], v[144:159]
buffer_load_dwordx4 v8, s[20:23], s41 offen offset:2048 lds
v_mfma_f32_32x32x16_bf16 v[128:143], v[204:207], a[120:123], v[128:143]
buffer_load_dwordx4 v9, s[20:23], s41 offen offset:3072 lds
v_mfma_f32_32x32x16_bf16 v[144:159], v[204:207], a[124:127], v[144:159]
v_mfma_f32_32x32x16_bf16 v[160:175], v[208:211], a[0:3], v[96:111]
s_waitcnt vmcnt(20)
ds_read_b128 v[192:195], v18 offset:4096
ds_read_b128 v[196:199], v19 offset:4096
v_mfma_f32_32x32x16_bf16 v[176:191], v[208:211], a[4:7], v[112:127]
ds_read_b128 v[200:203], v20 offset:4096
ds_read_b128 v[204:207], v21 offset:4096
v_mfma_f32_32x32x16_bf16 v[160:175], v[212:215], a[8:11], v[160:175]
s_nop 1
v_max_f32 v34, v128, v129
v_exp_f32 v128, v128
v_exp_f32 v129, v129
v_max3_f32 v34, v34, v130, v131
v_mfma_f32_32x32x16_bf16 v[176:191], v[212:215], a[12:15], v[176:191]
s_add_u32 m0, s40, 4096
s_mov_b32 s41, 33152
s_waitcnt lgkmcnt(0)
buffer_load_dwordx4 v6, s[20:23], s41 offen lds
v_exp_f32 v130, v130
v_exp_f32 v131, v131
v_mfma_f32_32x32x16_bf16 v[160:175], v[216:219], a[16:19], v[160:175]
buffer_load_dwordx4 v7, s[20:23], s41 offen offset:1024 lds
v_cvt_pk_bf16_f32 v80, v128, v129
v_add_f32 v36, v128, v129
v_max3_f32 v34, v34, v132, v133
v_exp_f32 v132, v132
v_mfma_f32_32x32x16_bf16 v[176:191], v[216:219], a[20:23], v[176:191]
buffer_load_dwordx4 v8, s[20:23], s41 offen offset:2048 lds
v_exp_f32 v133, v133
v_cvt_pk_bf16_f32 v81, v130, v131
v_add_f32 v36, v36, v130
v_mfma_f32_32x32x16_bf16 v[160:175], v[220:223], a[24:27], v[160:175]
buffer_load_dwordx4 v9, s[20:23], s41 offen offset:3072 lds
v_add_f32 v36, v36, v131
v_max3_f32 v34, v34, v134, v135
v_exp_f32 v134, v134
v_mfma_f32_32x32x16_bf16 v[176:191], v[220:223], a[28:31], v[176:191]
v_exp_f32 v135, v135
v_cvt_pk_bf16_f32 v82, v132, v133
v_add_f32 v36, v36, v132
v_add_f32 v36, v36, v133
v_max3_f32 v34, v34, v136, v137
v_mfma_f32_32x32x16_bf16 v[160:175], v[192:195], a[32:35], v[160:175]
s_waitcnt vmcnt(20)
ds_read_b128 v[208:211], v18 offset:8192
ds_read_b128 v[212:215], v19 offset:8192
v_exp_f32 v136, v136
v_exp_f32 v137, v137
v_mfma_f32_32x32x16_bf16 v[176:191], v[192:195], a[36:39], v[176:191]
ds_read_b128 v[216:219], v20 offset:8192
ds_read_b128 v[220:223], v21 offset:8192
v_cvt_pk_bf16_f32 v83, v134, v135
v_add_f32 v36, v36, v134
v_add_f32 v36, v36, v135
v_max3_f32 v34, v34, v138, v139
v_mfma_f32_32x32x16_bf16 v[160:175], v[196:199], a[40:43], v[160:175]
v_exp_f32 v138, v138
v_exp_f32 v139, v139
v_cvt_pk_bf16_f32 v84, v136, v137
v_add_f32 v36, v36, v136
v_mfma_f32_32x32x16_bf16 v[176:191], v[196:199], a[44:47], v[176:191]
s_add_u32 m0, s40, 8192
s_mov_b32 s41, 49152
s_waitcnt lgkmcnt(0)
buffer_load_dwordx4 v6, s[20:23], s41 offen lds
v_add_f32 v36, v36, v137
ds_write_b128 v30, v[80:83] offset:32768
v_mfma_f32_32x32x16_bf16 v[160:175], v[200:203], a[48:51], v[160:175]
buffer_load_dwordx4 v7, s[20:23], s41 offen offset:1024 lds
v_max3_f32 v34, v34, v140, v141
v_exp_f32 v140, v140
v_exp_f32 v141, v141
v_mfma_f32_32x32x16_bf16 v[176:191], v[200:203], a[52:55], v[176:191]
buffer_load_dwordx4 v8, s[20:23], s41 offen offset:2048 lds
v_cvt_pk_bf16_f32 v85, v138, v139
v_add_f32 v36, v36, v138
v_add_f32 v36, v36, v139
v_max3_f32 v34, v34, v142, v143
v_mfma_f32_32x32x16_bf16 v[160:175], v[204:207], a[56:59], v[160:175]
buffer_load_dwordx4 v9, s[20:23], s41 offen offset:3072 lds
v_exp_f32 v142, v142
v_exp_f32 v143, v143
v_mfma_f32_32x32x16_bf16 v[176:191], v[204:207], a[60:63], v[176:191]
v_cvt_pk_bf16_f32 v86, v140, v141
v_add_f32 v36, v36, v140
v_add_f32 v36, v36, v141
v_add_f32 v36, v36, v142
v_cvt_pk_bf16_f32 v87, v142, v143
v_add_f32 v36, v36, v143
v_mfma_f32_32x32x16_bf16 v[160:175], v[208:211], a[64:67], v[160:175]
s_waitcnt vmcnt(20)
ds_read_b128 v[192:195], v18 offset:12288
ds_read_b128 v[196:199], v19 offset:12288
ds_write_b128 v30, v[84:87] offset:34816
v_max_f32 v35, v144, v145
v_mfma_f32_32x32x16_bf16 v[176:191], v[208:211], a[68:71], v[176:191]
ds_read_b128 v[200:203], v20 offset:12288
ds_read_b128 v[204:207], v21 offset:12288
v_exp_f32 v144, v144
v_exp_f32 v145, v145
v_mfma_f32_32x32x16_bf16 v[160:175], v[212:215], a[72:75], v[160:175]
v_max3_f32 v35, v35, v146, v147
v_exp_f32 v146, v146
v_exp_f32 v147, v147
v_cvt_pk_bf16_f32 v88, v144, v145
v_mfma_f32_32x32x16_bf16 v[176:191], v[212:215], a[76:79], v[176:191]
s_add_u32 m0, s40, 12288
s_mov_b32 s41, 49280
s_waitcnt lgkmcnt(0)
buffer_load_dwordx4 v6, s[20:23], s41 offen lds
v_add_f32 v37, v144, v145
v_max3_f32 v35, v35, v148, v149
v_exp_f32 v148, v148
v_mfma_f32_32x32x16_bf16 v[160:175], v[216:219], a[80:83], v[160:175]
buffer_load_dwordx4 v7, s[20:23], s41 offen offset:1024 lds
v_exp_f32 v149, v149
v_cvt_pk_bf16_f32 v89, v146, v147
v_add_f32 v37, v37, v146
v_mfma_f32_32x32x16_bf16 v[176:191], v[216:219], a[84:87], v[176:191]
buffer_load_dwordx4 v8, s[20:23], s41 offen offset:2048 lds
v_add_f32 v37, v37, v147
v_max3_f32 v35, v35, v150, v151
v_exp_f32 v150, v150
v_mfma_f32_32x32x16_bf16 v[160:175], v[220:223], a[88:91], v[160:175]
buffer_load_dwordx4 v9, s[20:23], s41 offen offset:3072 lds
v_exp_f32 v151, v151
v_cvt_pk_bf16_f32 v90, v148, v149
v_add_f32 v37, v37, v148
v_mfma_f32_32x32x16_bf16 v[176:191], v[220:223], a[92:95], v[176:191]
v_add_f32 v37, v37, v149
v_max3_f32 v35, v35, v152, v153
v_exp_f32 v152, v152
v_exp_f32 v153, v153
v_mfma_f32_32x32x16_bf16 v[160:175], v[192:195], a[96:99], v[160:175]
s_waitcnt vmcnt(20)
ds_read_b128 v[224:227], v18 offset:16384
ds_read_b128 v[228:231], v19 offset:16384
v_cvt_pk_bf16_f32 v91, v150, v151
v_add_f32 v37, v37, v150
v_add_f32 v37, v37, v151
v_max3_f32 v35, v35, v154, v155
v_mfma_f32_32x32x16_bf16 v[176:191], v[192:195], a[100:103], v[176:191]
ds_read_b128 v[232:235], v20 offset:16384
ds_read_b128 v[236:239], v21 offset:16384
v_exp_f32 v154, v154
v_exp_f32 v155, v155
v_mfma_f32_32x32x16_bf16 v[160:175], v[196:199], a[104:107], v[160:175]
v_cvt_pk_bf16_f32 v92, v152, v153
v_add_f32 v37, v37, v152
v_add_f32 v37, v37, v153
ds_write_b128 v30, v[88:91] offset:33792
v_mfma_f32_32x32x16_bf16 v[176:191], v[196:199], a[108:111], v[176:191]
s_add_u32 m0, s40, 16384
s_mov_b32 s41, 49408
s_waitcnt lgkmcnt(1)
buffer_load_dwordx4 v6, s[20:23], s41 offen lds
v_max3_f32 v35, v35, v156, v157
v_exp_f32 v156, v156
v_exp_f32 v157, v157
v_mfma_f32_32x32x16_bf16 v[160:175], v[200:203], a[112:115], v[160:175]
buffer_load_dwordx4 v7, s[20:23], s41 offen offset:1024 lds
v_cvt_pk_bf16_f32 v93, v154, v155
v_add_f32 v37, v37, v154
v_add_f32 v37, v37, v155
v_max3_f32 v35, v35, v158, v159
v_mfma_f32_32x32x16_bf16 v[176:191], v[200:203], a[116:119], v[176:191]
buffer_load_dwordx4 v8, s[20:23], s41 offen offset:2048 lds
v_exp_f32 v158, v158
v_exp_f32 v159, v159
v_mfma_f32_32x32x16_bf16 v[160:175], v[204:207], a[120:123], v[160:175]
buffer_load_dwordx4 v9, s[20:23], s41 offen offset:3072 lds
v_cvt_pk_bf16_f32 v94, v156, v157
v_add_f32 v37, v37, v156
v_add_f32 v37, v37, v157
v_add_f32 v37, v37, v158
v_mfma_f32_32x32x16_bf16 v[176:191], v[204:207], a[124:127], v[176:191]
v_cvt_pk_bf16_f32 v95, v158, v159
v_add_f32 v37, v37, v159
ds_write_b128 v30, v[92:95] offset:35840
v_mfma_f32_32x32x16_bf16 v[192:207], v[224:227], a[0:3], v[96:111]
s_waitcnt vmcnt(20)
ds_read_b128 v[240:243], v18 offset:20480
ds_read_b128 v[244:247], v19 offset:20480
v_mfma_f32_32x32x16_bf16 v[208:223], v[224:227], a[4:7], v[112:127]
ds_read_b128 v[248:251], v20 offset:20480
ds_read_b128 v[252:255], v21 offset:20480
v_mfma_f32_32x32x16_bf16 v[192:207], v[228:231], a[8:11], v[192:207]
v_mfma_f32_32x32x16_bf16 v[208:223], v[228:231], a[12:15], v[208:223]
s_add_u32 m0, s40, 20480
s_mov_b32 s41, 49536
s_waitcnt lgkmcnt(0)
buffer_load_dwordx4 v6, s[20:23], s41 offen lds
v_mfma_f32_32x32x16_bf16 v[192:207], v[232:235], a[16:19], v[192:207]
buffer_load_dwordx4 v7, s[20:23], s41 offen offset:1024 lds
v_mfma_f32_32x32x16_bf16 v[208:223], v[232:235], a[20:23], v[208:223]
buffer_load_dwordx4 v8, s[20:23], s41 offen offset:2048 lds
v_mfma_f32_32x32x16_bf16 v[192:207], v[236:239], a[24:27], v[192:207]
buffer_load_dwordx4 v9, s[20:23], s41 offen offset:3072 lds
v_mfma_f32_32x32x16_bf16 v[208:223], v[236:239], a[28:31], v[208:223]
v_mfma_f32_32x32x16_bf16 v[192:207], v[240:243], a[32:35], v[192:207]
s_waitcnt vmcnt(20)
ds_read_b128 v[224:227], v18 offset:0
ds_read_b128 v[228:231], v19 offset:0
v_mfma_f32_32x32x16_bf16 v[208:223], v[240:243], a[36:39], v[208:223]
ds_read_b128 v[232:235], v20 offset:0
ds_read_b128 v[236:239], v21 offset:0
v_mfma_f32_32x32x16_bf16 v[192:207], v[244:247], a[40:43], v[192:207]
v_mfma_f32_32x32x16_bf16 v[208:223], v[244:247], a[44:47], v[208:223]
s_add_u32 m0, s40, 0
s_mov_b32 s41, 0
s_waitcnt lgkmcnt(0)
buffer_load_dwordx4 v10, s[24:27], s41 offen lds
v_mfma_f32_32x32x16_bf16 v[192:207], v[248:251], a[48:51], v[192:207]
buffer_load_dwordx4 v11, s[24:27], s41 offen offset:1024 lds
v_mfma_f32_32x32x16_bf16 v[208:223], v[248:251], a[52:55], v[208:223]
buffer_load_dwordx4 v12, s[24:27], s41 offen offset:2048 lds
v_mfma_f32_32x32x16_bf16 v[192:207], v[252:255], a[56:59], v[192:207]
buffer_load_dwordx4 v13, s[24:27], s41 offen offset:3072 lds
v_mfma_f32_32x32x16_bf16 v[208:223], v[252:255], a[60:63], v[208:223]
s_waitcnt lgkmcnt(0)
s_barrier
v_mfma_f32_32x32x16_bf16 v[192:207], v[224:227], a[64:67], v[192:207]
s_waitcnt vmcnt(20)
ds_read_b128 v[240:243], v18 offset:4096
ds_read_b128 v[244:247], v19 offset:4096
v_mfma_f32_32x32x16_bf16 v[208:223], v[224:227], a[68:71], v[208:223]
ds_read_b128 v[248:251], v20 offset:4096
ds_read_b128 v[252:255], v21 offset:4096
v_mfma_f32_32x32x16_bf16 v[192:207], v[228:231], a[72:75], v[192:207]
v_max3_f32 v34, v34, v160, v161
v_exp_f32 v160, v160
v_exp_f32 v161, v161
v_max3_f32 v34, v34, v162, v163
v_mfma_f32_32x32x16_bf16 v[208:223], v[228:231], a[76:79], v[208:223]
s_add_u32 m0, s40, 4096
s_mov_b32 s41, 65536
s_waitcnt lgkmcnt(0)
buffer_load_dwordx4 v10, s[24:27], s41 offen lds
v_exp_f32 v162, v162
v_exp_f32 v163, v163
v_mfma_f32_32x32x16_bf16 v[192:207], v[232:235], a[80:83], v[192:207]
buffer_load_dwordx4 v11, s[24:27], s41 offen offset:1024 lds
v_cvt_pk_bf16_f32 v80, v160, v161
v_add_f32 v36, v36, v160
v_add_f32 v36, v36, v161
v_max3_f32 v34, v34, v164, v165
v_mfma_f32_32x32x16_bf16 v[208:223], v[232:235], a[84:87], v[208:223]
buffer_load_dwordx4 v12, s[24:27], s41 offen offset:2048 lds
v_exp_f32 v164, v164
v_exp_f32 v165, v165
v_mfma_f32_32x32x16_bf16 v[192:207], v[236:239], a[88:91], v[192:207]
buffer_load_dwordx4 v13, s[24:27], s41 offen offset:3072 lds
v_cvt_pk_bf16_f32 v81, v162, v163
v_add_f32 v36, v36, v162
v_add_f32 v36, v36, v163
v_max3_f32 v34, v34, v166, v167
v_mfma_f32_32x32x16_bf16 v[208:223], v[236:239], a[92:95], v[208:223]
v_exp_f32 v166, v166
v_exp_f32 v167, v167
v_cvt_pk_bf16_f32 v82, v164, v165
v_add_f32 v36, v36, v164
v_mfma_f32_32x32x16_bf16 v[192:207], v[240:243], a[96:99], v[192:207]
s_waitcnt vmcnt(20)
ds_read_b128 v[48:51], v18 offset:8192
ds_read_b128 v[52:55], v19 offset:8192
v_add_f32 v36, v36, v165
v_max3_f32 v34, v34, v168, v169
v_exp_f32 v168, v168
v_mfma_f32_32x32x16_bf16 v[208:223], v[240:243], a[100:103], v[208:223]
ds_read_b128 v[56:59], v20 offset:8192
ds_read_b128 v[60:63], v21 offset:8192
v_exp_f32 v169, v169
v_cvt_pk_bf16_f32 v83, v166, v167
v_add_f32 v36, v36, v166
v_mfma_f32_32x32x16_bf16 v[192:207], v[244:247], a[104:107], v[192:207]
v_add_f32 v36, v36, v167
v_max3_f32 v34, v34, v170, v171
v_exp_f32 v170, v170
v_exp_f32 v171, v171
v_mfma_f32_32x32x16_bf16 v[208:223], v[244:247], a[108:111], v[208:223]
s_add_u32 m0, s40, 8192
s_mov_b32 s41, 131072
s_waitcnt lgkmcnt(0)
buffer_load_dwordx4 v10, s[24:27], s41 offen lds
v_cvt_pk_bf16_f32 v84, v168, v169
v_add_f32 v36, v36, v168
v_add_f32 v36, v36, v169
ds_write_b128 v30, v[80:83] offset:49152
v_mfma_f32_32x32x16_bf16 v[192:207], v[248:251], a[112:115], v[192:207]
buffer_load_dwordx4 v11, s[24:27], s41 offen offset:1024 lds
v_max3_f32 v34, v34, v172, v173
v_exp_f32 v172, v172
v_exp_f32 v173, v173
v_mfma_f32_32x32x16_bf16 v[208:223], v[248:251], a[116:119], v[208:223]
buffer_load_dwordx4 v12, s[24:27], s41 offen offset:2048 lds
v_cvt_pk_bf16_f32 v85, v170, v171
v_add_f32 v36, v36, v170
v_add_f32 v36, v36, v171
v_max3_f32 v34, v34, v174, v175
v_mfma_f32_32x32x16_bf16 v[192:207], v[252:255], a[120:123], v[192:207]
buffer_load_dwordx4 v13, s[24:27], s41 offen offset:3072 lds
v_exp_f32 v174, v174
v_exp_f32 v175, v175
v_mfma_f32_32x32x16_bf16 v[208:223], v[252:255], a[124:127], v[208:223]
v_cvt_pk_bf16_f32 v86, v172, v173
v_add_f32 v36, v36, v172
v_add_f32 v36, v36, v173
v_add_f32 v36, v36, v174
v_cvt_pk_bf16_f32 v87, v174, v175
v_add_f32 v36, v36, v175
v_mfma_f32_32x32x16_bf16 v[224:239], v[48:51], a[0:3], v[96:111]
s_waitcnt vmcnt(20)
ds_read_b128 v[64:67], v18 offset:12288
ds_read_b128 v[68:71], v19 offset:12288
ds_write_b128 v30, v[84:87] offset:51200
v_max3_f32 v35, v35, v176, v177
v_mfma_f32_32x32x16_bf16 v[240:255], v[48:51], a[4:7], v[112:127]
ds_read_b128 v[72:75], v20 offset:12288
ds_read_b128 v[76:79], v21 offset:12288
v_exp_f32 v176, v176
v_exp_f32 v177, v177
v_mfma_f32_32x32x16_bf16 v[224:239], v[52:55], a[8:11], v[224:239]
v_max3_f32 v35, v35, v178, v179
v_exp_f32 v178, v178
v_exp_f32 v179, v179
v_cvt_pk_bf16_f32 v88, v176, v177
v_mfma_f32_32x32x16_bf16 v[240:255], v[52:55], a[12:15], v[240:255]
s_add_u32 m0, s40, 12288
s_mov_b32 s41, 196608
s_waitcnt lgkmcnt(0)
buffer_load_dwordx4 v10, s[24:27], s41 offen lds
v_add_f32 v37, v37, v176
v_add_f32 v37, v37, v177
v_max3_f32 v35, v35, v180, v181
v_exp_f32 v180, v180
v_mfma_f32_32x32x16_bf16 v[224:239], v[56:59], a[16:19], v[224:239]
buffer_load_dwordx4 v11, s[24:27], s41 offen offset:1024 lds
v_exp_f32 v181, v181
v_cvt_pk_bf16_f32 v89, v178, v179
v_add_f32 v37, v37, v178
v_mfma_f32_32x32x16_bf16 v[240:255], v[56:59], a[20:23], v[240:255]
buffer_load_dwordx4 v12, s[24:27], s41 offen offset:2048 lds
v_add_f32 v37, v37, v179
v_max3_f32 v35, v35, v182, v183
v_exp_f32 v182, v182
v_mfma_f32_32x32x16_bf16 v[224:239], v[60:63], a[24:27], v[224:239]
buffer_load_dwordx4 v13, s[24:27], s41 offen offset:3072 lds
v_exp_f32 v183, v183
v_cvt_pk_bf16_f32 v90, v180, v181
v_add_f32 v37, v37, v180
v_mfma_f32_32x32x16_bf16 v[240:255], v[60:63], a[28:31], v[240:255]
v_add_f32 v37, v37, v181
v_max3_f32 v35, v35, v184, v185
v_exp_f32 v184, v184
v_exp_f32 v185, v185
s_cmp_lg_u32 s9, 0
s_cbranch_scc1 L_nn1A
v_mov_b32 v42, s88
global_load_dwordx2 v[40:41], v42, s[38:39] sc1
L_nn1A:
v_mfma_f32_32x32x16_bf16 v[224:239], v[64:67], a[32:35], v[224:239]
s_waitcnt vmcnt(20)
ds_read_b128 v[48:51], v18 offset:16384
ds_read_b128 v[52:55], v19 offset:16384
v_cvt_pk_bf16_f32 v91, v182, v183
v_add_f32 v37, v37, v182
v_add_f32 v37, v37, v183
s_nop 4
v_max3_f32 v35, v35, v186, v187
v_mfma_f32_32x32x16_bf16 v[240:255], v[64:67], a[36:39], v[240:255]
ds_read_b128 v[56:59], v20 offset:16384
ds_read_b128 v[60:63], v21 offset:16384
v_exp_f32 v186, v186
v_exp_f32 v187, v187
v_mfma_f32_32x32x16_bf16 v[224:239], v[68:71], a[40:43], v[224:239]
v_cvt_pk_bf16_f32 v92, v184, v185
v_add_f32 v37, v37, v184
v_add_f32 v37, v37, v185
ds_write_b128 v30, v[88:91] offset:50176
v_mfma_f32_32x32x16_bf16 v[240:255], v[68:71], a[44:47], v[240:255]
s_add_u32 m0, s40, 16384
s_mov_b32 s41, 16384
s_waitcnt lgkmcnt(1)
buffer_load_dwordx4 v10, s[24:27], s41 offen lds
v_max3_f32 v35, v35, v188, v189
v_exp_f32 v188, v188
v_exp_f32 v189, v189
v_mfma_f32_32x32x16_bf16 v[224:239], v[72:75], a[48:51], v[224:239]
buffer_load_dwordx4 v11, s[24:27], s41 offen offset:1024 lds
v_cvt_pk_bf16_f32 v93, v186, v187
v_add_f32 v37, v37, v186
v_add_f32 v37, v37, v187
v_max3_f32 v35, v35, v190, v191
v_mfma_f32_32x32x16_bf16 v[240:255], v[72:75], a[52:55], v[240:255]
buffer_load_dwordx4 v12, s[24:27], s41 offen offset:2048 lds
v_exp_f32 v190, v190
v_exp_f32 v191, v191
v_mfma_f32_32x32x16_bf16 v[224:239], v[76:79], a[56:59], v[224:239]
buffer_load_dwordx4 v13, s[24:27], s41 offen offset:3072 lds
v_cvt_pk_bf16_f32 v94, v188, v189
v_add_f32 v37, v37, v188
v_add_f32 v37, v37, v189
v_add_f32 v37, v37, v190
v_mfma_f32_32x32x16_bf16 v[240:255], v[76:79], a[60:63], v[240:255]
v_cvt_pk_bf16_f32 v95, v190, v191
v_add_f32 v37, v37, v191
ds_write_b128 v30, v[92:95] offset:52224
v_mfma_f32_32x32x16_bf16 v[224:239], v[48:51], a[64:67], v[224:239]
s_waitcnt vmcnt(20)
ds_read_b128 v[64:67], v18 offset:20480
ds_read_b128 v[68:71], v19 offset:20480
v_mfma_f32_32x32x16_bf16 v[240:255], v[48:51], a[68:71], v[240:255]
ds_read_b128 v[72:75], v20 offset:20480
ds_read_b128 v[76:79], v21 offset:20480
v_mfma_f32_32x32x16_bf16 v[224:239], v[52:55], a[72:75], v[224:239]
v_mfma_f32_32x32x16_bf16 v[240:255], v[52:55], a[76:79], v[240:255]
s_add_u32 m0, s40, 20480
s_mov_b32 s41, 81920
s_waitcnt lgkmcnt(0)
buffer_load_dwordx4 v10, s[24:27], s41 offen lds
v_mfma_f32_32x32x16_bf16 v[224:239], v[56:59], a[80:83], v[224:239]
buffer_load_dwordx4 v11, s[24:27], s41 offen offset:1024 lds
v_mfma_f32_32x32x16_bf16 v[240:255], v[56:59], a[84:87], v[240:255]
buffer_load_dwordx4 v12, s[24:27], s41 offen offset:2048 lds
v_mfma_f32_32x32x16_bf16 v[224:239], v[60:63], a[88:91], v[224:239]
buffer_load_dwordx4 v13, s[24:27], s41 offen offset:3072 lds
v_mfma_f32_32x32x16_bf16 v[240:255], v[60:63], a[92:95], v[240:255]
v_mfma_f32_32x32x16_bf16 v[224:239], v[64:67], a[96:99], v[224:239]
ds_read_b128 v[48:51], v28 offset:32768
ds_read_b128 v[52:55], v28 offset:33792
ds_read_b128 v[56:59], v28 offset:34816
v_mfma_f32_32x32x16_bf16 v[240:255], v[64:67], a[100:103], v[240:255]
ds_read_b128 v[60:63], v28 offset:35840
s_waitcnt vmcnt(20)
ds_read_b64_tr_b16 a[128:129], v24 offset:0
v_mfma_f32_32x32x16_bf16 v[224:239], v[68:71], a[104:107], v[224:239]
ds_read_b64_tr_b16 a[130:131], v24 offset:1024
ds_read_b64_tr_b16 a[132:133], v25 offset:0
ds_read_b64_tr_b16 a[134:135], v25 offset:1024
v_mfma_f32_32x32x16_bf16 v[240:255], v[68:71], a[108:111], v[240:255]
ds_read_b64_tr_b16 a[136:137], v24 offset:2048
ds_read_b64_tr_b16 a[138:139], v24 offset:3072
ds_read_b64_tr_b16 a[140:141], v25 offset:2048
v_mfma_f32_32x32x16_bf16 v[224:239], v[72:75], a[112:115], v[224:239]
ds_read_b64_tr_b16 a[142:143], v25 offset:3072
v_mfma_f32_32x32x16_bf16 v[240:255], v[72:75], a[116:119], v[240:255]
v_mfma_f32_32x32x16_bf16 v[224:239], v[76:79], a[120:123], v[224:239]
s_add_u32 m0, s40, 0
s_mov_b32 s41, 147456
s_waitcnt lgkmcnt(0)
buffer_load_dwordx4 v10, s[24:27], s41 offen lds
v_mfma_f32_32x32x16_bf16 v[240:255], v[76:79], a[124:127], v[240:255]
buffer_load_dwordx4 v11, s[24:27], s41 offen offset:1024 lds
s_waitcnt lgkmcnt(0)
s_barrier
v_mfma_f32_32x32x16_bf16 v[128:143], a[128:131], v[48:51], 0
ds_read_b128 v[64:67], v28 offset:36864
ds_read_b128 v[68:71], v28 offset:37888
ds_read_b128 v[72:75], v28 offset:38912
buffer_load_dwordx4 v12, s[24:27], s41 offen offset:2048 lds
v_mfma_f32_32x32x16_bf16 v[144:159], a[128:131], v[52:55], 0
ds_read_b128 v[76:79], v28 offset:39936
s_waitcnt vmcnt(19)
ds_read_b64_tr_b16 a[0:1], v24 offset:4096
buffer_load_dwordx4 v13, s[24:27], s41 offen offset:3072 lds
v_mfma_f32_32x32x16_bf16 v[160:175], a[132:135], v[48:51], 0
ds_read_b64_tr_b16 a[2:3], v24 offset:5120
ds_read_b64_tr_b16 a[4:5], v25 offset:4096
ds_read_b64_tr_b16 a[6:7], v25 offset:5120
v_max3_f32 v34, v34, v192, v193
v_exp_f32 v192, v192
v_exp_f32 v193, v193
v_mfma_f32_32x32x16_bf16 v[176:191], a[132:135], v[52:55], 0
ds_read_b64_tr_b16 a[8:9], v24 offset:6144
ds_read_b64_tr_b16 a[10:11], v24 offset:7168
ds_read_b64_tr_b16 a[12:13], v25 offset:6144
v_max3_f32 v34, v34, v194, v195
v_exp_f32 v194, v194
v_exp_f32 v195, v195
v_mfma_f32_32x32x16_bf16 v[128:143], a[136:139], v[56:59], v[128:143]
ds_read_b64_tr_b16 a[14:15], v25 offset:7168
v_cvt_pk_bf16_f32 v80, v192, v193
v_add_f32 v36, v36, v192
v_add_f32 v36, v36, v193
v_max3_f32 v34, v34, v196, v197
v_mfma_f32_32x32x16_bf16 v[144:159], a[136:139], v[60:63], v[144:159]
v_exp_f32 v196, v196
v_exp_f32 v197, v197
v_cvt_pk_bf16_f32 v81, v194, v195
v_add_f32 v36, v36, v194
v_mfma_f32_32x32x16_bf16 v[160:175], a[140:143], v[56:59], v[160:175]
s_add_u32 m0, s40, 4096
s_mov_b32 s41, 212992
s_waitcnt lgkmcnt(0)
buffer_load_dwordx4 v10, s[24:27], s41 offen lds
v_add_f32 v36, v36, v195
v_max3_f32 v34, v34, v198, v199
v_exp_f32 v198, v198
v_mfma_f32_32x32x16_bf16 v[176:191], a[140:143], v[60:63], v[176:191]
buffer_load_dwordx4 v11, s[24:27], s41 offen offset:1024 lds
v_exp_f32 v199, v199
v_cvt_pk_bf16_f32 v82, v196, v197
v_add_f32 v36, v36, v196
v_mfma_f32_32x32x16_bf16 v[128:143], a[0:3], v[64:67], v[128:143]
ds_read_b128 v[48:51], v28 offset:40960
ds_read_b128 v[52:55], v28 offset:41984
ds_read_b128 v[56:59], v28 offset:43008
buffer_load_dwordx4 v12, s[24:27], s41 offen offset:2048 lds
v_add_f32 v36, v36, v197
v_max3_f32 v34, v34, v200, v201
v_exp_f32 v200, v200
v_mfma_f32_32x32x16_bf16 v[144:159], a[0:3], v[68:71], v[144:159]
ds_read_b128 v[60:63], v28 offset:44032
s_waitcnt vmcnt(19)
ds_read_b64_tr_b16 a[16:17], v24 offset:8192
buffer_load_dwordx4 v13, s[24:27], s41 offen offset:3072 lds
v_exp_f32 v201, v201
v_cvt_pk_bf16_f32 v83, v198, v199
v_add_f32 v36, v36, v198
v_mfma_f32_32x32x16_bf16 v[160:175], a[4:7], v[64:67], v[160:175]
ds_read_b64_tr_b16 a[18:19], v24 offset:9216
ds_read_b64_tr_b16 a[20:21], v25 offset:8192
ds_read_b64_tr_b16 a[22:23], v25 offset:9216
v_add_f32 v36, v36, v199
v_max3_f32 v34, v34, v202, v203
v_exp_f32 v202, v202
v_mfma_f32_32x32x16_bf16 v[176:191], a[4:7], v[68:71], v[176:191]
ds_read_b64_tr_b16 a[24:25], v24 offset:10240
ds_read_b64_tr_b16 a[26:27], v24 offset:11264
ds_read_b64_tr_b16 a[28:29], v25 offset:10240
v_exp_f32 v203, v203
v_cvt_pk_bf16_f32 v84, v200, v201
v_add_f32 v36, v36, v200
v_mfma_f32_32x32x16_bf16 v[128:143], a[8:11], v[72:75], v[128:143]
ds_read_b64_tr_b16 a[30:31], v25 offset:11264
v_add_f32 v36, v36, v201
ds_write_b128 v30, v[80:83] offset:0
v_mfma_f32_32x32x16_bf16 v[144:159], a[8:11], v[76:79], v[144:159]
v_max3_f32 v34, v34, v204, v205
v_exp_f32 v204, v204
v_exp_f32 v205, v205
v_cvt_pk_bf16_f32 v85, v202, v203
v_mfma_f32_32x32x16_bf16 v[160:175], a[12:15], v[72:75], v[160:175]
s_add_u32 m0, s40, 8192
s_mov_b32 s41, 32768
s_waitcnt lgkmcnt(1)
buffer_load_dwordx4 v10, s[24:27], s41 offen lds
v_add_f32 v36, v36, v202
v_add_f32 v36, v36, v203
v_max3_f32 v34, v34, v206, v207
v_exp_f32 v206, v206
v_mfma_f32_32x32x16_bf16 v[176:191], a[12:15], v[76:79], v[176:191]
buffer_load_dwordx4 v11, s[24:27], s41 offen offset:1024 lds
v_exp_f32 v207, v207
v_cvt_pk_bf16_f32 v86, v204, v205
v_add_f32 v36, v36, v204
v_mfma_f32_32x32x16_bf16 v[128:143], a[16:19], v[48:51], v[128:143]
ds_read_b128 v[64:67], v28 offset:45056
ds_read_b128 v[68:71], v28 offset:46080
ds_read_b128 v[72:75], v28 offset:47104
buffer_load_dwordx4 v12, s[24:27], s41 offen offset:2048 lds
v_add_f32 v36, v36, v205
v_add_f32 v36, v36, v206
v_cvt_pk_bf16_f32 v87, v206, v207
v_add_f32 v36, v36, v207
v_mfma_f32_32x32x16_bf16 v[144:159], a[16:19], v[52:55], v[144:159]
ds_read_b128 v[76:79], v28 offset:48128
s_waitcnt vmcnt(19)
ds_read_b64_tr_b16 a[0:1], v24 offset:12288
buffer_load_dwordx4 v13, s[24:27], s41 offen offset:3072 lds
ds_write_b128 v30, v[84:87] offset:2048
v_max3_f32 v35, v35, v208, v209
v_mfma_f32_32x32x16_bf16 v[160:175], a[20:23], v[48:51], v[160:175]
ds_read_b64_tr_b16 a[2:3], v24 offset:13312
ds_read_b64_tr_b16 a[4:5], v25 offset:12288
ds_read_b64_tr_b16 a[6:7], v25 offset:13312
v_exp_f32 v208, v208
v_exp_f32 v209, v209
v_mfma_f32_32x32x16_bf16 v[176:191], a[20:23], v[52:55], v[176:191]
ds_read_b64_tr_b16 a[8:9], v24 offset:14336
ds_read_b64_tr_b16 a[10:11], v24 offset:15360
ds_read_b64_tr_b16 a[12:13], v25 offset:14336
v_max3_f32 v35, v35, v210, v211
v_exp_f32 v210, v210
v_exp_f32 v211, v211
v_mfma_f32_32x32x16_bf16 v[128:143], a[24:27], v[56:59], v[128:143]
ds_read_b64_tr_b16 a[14:15], v25 offset:15360
v_cvt_pk_bf16_f32 v88, v208, v209
v_add_f32 v37, v37, v208
v_add_f32 v37, v37, v209
v_max3_f32 v35, v35, v212, v213
v_mfma_f32_32x32x16_bf16 v[144:159], a[24:27], v[60:63], v[144:159]
v_exp_f32 v212, v212
v_exp_f32 v213, v213
v_cvt_pk_bf16_f32 v89, v210, v211
v_add_f32 v37, v37, v210
v_mfma_f32_32x32x16_bf16 v[160:175], a[28:31], v[56:59], v[160:175]
s_add_u32 m0, s40, 12288
s_mov_b32 s41, 98304
s_waitcnt lgkmcnt(0)
buffer_load_dwordx4 v10, s[24:27], s41 offen lds
v_add_f32 v37, v37, v211
v_max3_f32 v35, v35, v214, v215
v_exp_f32 v214, v214
v_mfma_f32_32x32x16_bf16 v[176:191], a[28:31], v[60:63], v[176:191]
buffer_load_dwordx4 v11, s[24:27], s41 offen offset:1024 lds
v_exp_f32 v215, v215
v_cvt_pk_bf16_f32 v90, v212, v213
v_add_f32 v37, v37, v212
v_mfma_f32_32x32x16_bf16 v[128:143], a[0:3], v[64:67], v[128:143]
ds_read_b128 v[48:51], v28 offset:49152
ds_read_b128 v[52:55], v28 offset:50176
ds_read_b128 v[56:59], v28 offset:51200
buffer_load_dwordx4 v12, s[24:27], s41 offen offset:2048 lds
v_add_f32 v37, v37, v213
v_max3_f32 v35, v35, v216, v217
v_exp_f32 v216, v216
v_mfma_f32_32x32x16_bf16 v[144:159], a[0:3], v[68:71], v[144:159]
ds_read_b128 v[60:63], v28 offset:52224
s_waitcnt vmcnt(19)
ds_read_b64_tr_b16 a[16:17], v24 offset:16384
buffer_load_dwordx4 v13, s[24:27], s41 offen offset:3072 lds
v_exp_f32 v217, v217
v_cvt_pk_bf16_f32 v91, v214, v215
v_add_f32 v37, v37, v214
v_mfma_f32_32x32x16_bf16 v[160:175], a[4:7], v[64:67], v[160:175]
ds_read_b64_tr_b16 a[18:19], v24 offset:17408
ds_read_b64_tr_b16 a[20:21], v25 offset:16384
ds_read_b64_tr_b16 a[22:23], v25 offset:17408
v_add_f32 v37, v37, v215
v_max3_f32 v35, v35, v218, v219
v_exp_f32 v218, v218
v_mfma_f32_32x32x16_bf16 v[176:191], a[4:7], v[68:71], v[176:191]
ds_read_b64_tr_b16 a[24:25], v24 offset:18432
ds_read_b64_tr_b16 a[26:27], v24 offset:19456
ds_read_b64_tr_b16 a[28:29], v25 offset:18432
v_exp_f32 v219, v219
v_cvt_pk_bf16_f32 v92, v216, v217
v_add_f32 v37, v37, v216
v_mfma_f32_32x32x16_bf16 v[128:143], a[8:11], v[72:75], v[128:143]
ds_read_b64_tr_b16 a[30:31], v25 offset:19456
v_add_f32 v37, v37, v217
ds_write_b128 v30, v[88:91] offset:1024
v_mfma_f32_32x32x16_bf16 v[144:159], a[8:11], v[76:79], v[144:159]
v_max3_f32 v35, v35, v220, v221
v_exp_f32 v220, v220
v_exp_f32 v221, v221
v_cvt_pk_bf16_f32 v93, v218, v219
v_mfma_f32_32x32x16_bf16 v[160:175], a[12:15], v[72:75], v[160:175]
s_add_u32 m0, s40, 16384
s_mov_b32 s41, 163840
s_waitcnt lgkmcnt(1)
buffer_load_dwordx4 v10, s[24:27], s41 offen lds
v_add_f32 v37, v37, v218
v_add_f32 v37, v37, v219
v_max3_f32 v35, v35, v222, v223
v_exp_f32 v222, v222
v_mfma_f32_32x32x16_bf16 v[176:191], a[12:15], v[76:79], v[176:191]
buffer_load_dwordx4 v11, s[24:27], s41 offen offset:1024 lds
v_exp_f32 v223, v223
v_cvt_pk_bf16_f32 v94, v220, v221
v_add_f32 v37, v37, v220
v_mfma_f32_32x32x16_bf16 v[128:143], a[16:19], v[48:51], v[128:143]
ds_read_b128 v[64:67], v28 offset:53248
ds_read_b128 v[68:71], v28 offset:54272
ds_read_b128 v[72:75], v28 offset:55296
buffer_load_dwordx4 v12, s[24:27], s41 offen offset:2048 lds
v_add_f32 v37, v37, v221
v_add_f32 v37, v37, v222
v_cvt_pk_bf16_f32 v95, v222, v223
v_add_f32 v37, v37, v223
v_mfma_f32_32x32x16_bf16 v[144:159], a[16:19], v[52:55], v[144:159]
ds_read_b128 v[76:79], v28 offset:56320
s_waitcnt vmcnt(19)
ds_read_b64_tr_b16 a[0:1], v24 offset:20480
buffer_load_dwordx4 v13, s[24:27], s41 offen offset:3072 lds
ds_write_b128 v30, v[92:95] offset:3072
v_mfma_f32_32x32x16_bf16 v[160:175], a[20:23], v[48:51], v[160:175]
ds_read_b64_tr_b16 a[2:3], v24 offset:21504
ds_read_b64_tr_b16 a[4:5], v25 offset:20480
ds_read_b64_tr_b16 a[6:7], v25 offset:21504
v_mfma_f32_32x32x16_bf16 v[176:191], a[20:23], v[52:55], v[176:191]
ds_read_b64_tr_b16 a[8:9], v24 offset:22528
ds_read_b64_tr_b16 a[10:11], v24 offset:23552
ds_read_b64_tr_b16 a[12:13], v25 offset:22528
v_mfma_f32_32x32x16_bf16 v[128:143], a[24:27], v[56:59], v[128:143]
ds_read_b64_tr_b16 a[14:15], v25 offset:23552
v_mfma_f32_32x32x16_bf16 v[144:159], a[24:27], v[60:63], v[144:159]
v_mfma_f32_32x32x16_bf16 v[160:175], a[28:31], v[56:59], v[160:175]
s_add_u32 s50, s7, 0
s_and_b32 s50, s50, 7
s_mul_i32 s50, s50, 28672
s_add_u32 m0, s40, 20480
s_add_u32 s41, s50, 0
s_waitcnt lgkmcnt(0)
buffer_load_dwordx4 v14, s[28:31], s41 offen lds
v_mfma_f32_32x32x16_bf16 v[176:191], a[28:31], v[60:63], v[176:191]
buffer_load_dwordx4 v15, s[28:31], s41 offen offset:1024 lds
v_mfma_f32_32x32x16_bf16 v[128:143], a[0:3], v[64:67], v[128:143]
ds_read_b128 v[48:51], v28 offset:57344
ds_read_b128 v[52:55], v28 offset:58368
ds_read_b128 v[56:59], v28 offset:59392
buffer_load_dwordx4 v16, s[28:31], s41 offen offset:2048 lds
v_mfma_f32_32x32x16_bf16 v[144:159], a[0:3], v[68:71], v[144:159]
ds_read_b128 v[60:63], v28 offset:60416
s_waitcnt vmcnt(19)
ds_read_b64_tr_b16 a[16:17], v24 offset:0
buffer_load_dwordx4 v17, s[28:31], s41 offen offset:3072 lds
v_mfma_f32_32x32x16_bf16 v[160:175], a[4:7], v[64:67], v[160:175]
ds_read_b64_tr_b16 a[18:19], v24 offset:1024
ds_read_b64_tr_b16 a[20:21], v25 offset:0
ds_read_b64_tr_b16 a[22:23], v25 offset:1024
v_mfma_f32_32x32x16_bf16 v[176:191], a[4:7], v[68:71], v[176:191]
ds_read_b64_tr_b16 a[24:25], v24 offset:2048
ds_read_b64_tr_b16 a[26:27], v24 offset:3072
ds_read_b64_tr_b16 a[28:29], v25 offset:2048
v_mfma_f32_32x32x16_bf16 v[128:143], a[8:11], v[72:75], v[128:143]
ds_read_b64_tr_b16 a[30:31], v25 offset:3072
v_mfma_f32_32x32x16_bf16 v[144:159], a[8:11], v[76:79], v[144:159]
v_mfma_f32_32x32x16_bf16 v[160:175], a[12:15], v[72:75], v[160:175]
s_add_u32 m0, s40, 0
s_mov_b32 s41, 229376
s_waitcnt lgkmcnt(0)
buffer_load_dwordx4 v10, s[24:27], s41 offen lds
v_mfma_f32_32x32x16_bf16 v[176:191], a[12:15], v[76:79], v[176:191]
buffer_load_dwordx4 v11, s[24:27], s41 offen offset:1024 lds
s_waitcnt lgkmcnt(0)
s_barrier
v_mfma_f32_32x32x16_bf16 v[128:143], a[16:19], v[48:51], v[128:143]
ds_read_b128 v[64:67], v28 offset:61440
ds_read_b128 v[68:71], v28 offset:62464
ds_read_b128 v[72:75], v28 offset:63488
buffer_load_dwordx4 v12, s[24:27], s41 offen offset:2048 lds
v_mfma_f32_32x32x16_bf16 v[144:159], a[16:19], v[52:55], v[144:159]
ds_read_b128 v[76:79], v28 offset:64512
s_waitcnt vmcnt(19)
ds_read_b64_tr_b16 a[0:1], v24 offset:4096
buffer_load_dwordx4 v13, s[24:27], s41 offen offset:3072 lds
v_mfma_f32_32x32x16_bf16 v[160:175], a[20:23], v[48:51], v[160:175]
ds_read_b64_tr_b16 a[2:3], v24 offset:5120
ds_read_b64_tr_b16 a[4:5], v25 offset:4096
ds_read_b64_tr_b16 a[6:7], v25 offset:5120
v_max3_f32 v34, v34, v224, v225
v_exp_f32 v224, v224
v_exp_f32 v225, v225
v_mfma_f32_32x32x16_bf16 v[176:191], a[20:23], v[52:55], v[176:191]
ds_read_b64_tr_b16 a[8:9], v24 offset:6144
ds_read_b64_tr_b16 a[10:11], v24 offset:7168
ds_read_b64_tr_b16 a[12:13], v25 offset:6144
v_max3_f32 v34, v34, v226, v227
v_exp_f32 v226, v226
v_exp_f32 v227, v227
v_mfma_f32_32x32x16_bf16 v[128:143], a[24:27], v[56:59], v[128:143]
ds_read_b64_tr_b16 a[14:15], v25 offset:7168
v_cvt_pk_bf16_f32 v80, v224, v225
v_add_f32 v36, v36, v224
v_add_f32 v36, v36, v225
v_max3_f32 v34, v34, v228, v229
v_exp_f32 v228, v228
v_mfma_f32_32x32x16_bf16 v[144:159], a[24:27], v[60:63], v[144:159]
v_exp_f32 v229, v229
v_cvt_pk_bf16_f32 v81, v226, v227
v_add_f32 v36, v36, v226
v_add_f32 v36, v36, v227
v_max3_f32 v34, v34, v230, v231
v_mfma_f32_32x32x16_bf16 v[160:175], a[28:31], v[56:59], v[160:175]
s_add_u32 s50, s7, 0
s_and_b32 s50, s50, 7
s_mul_i32 s50, s50, 28672
s_add_u32 m0, s40, 4096
s_add_u32 s41, s50, 128
s_waitcnt lgkmcnt(0)
buffer_load_dwordx4 v14, s[44:47], s41 offen lds
v_exp_f32 v230, v230
v_exp_f32 v231, v231
v_cvt_pk_bf16_f32 v82, v228, v229
v_mfma_f32_32x32x16_bf16 v[176:191], a[28:31], v[60:63], v[176:191]
buffer_load_dwordx4 v15, s[44:47], s41 offen offset:1024 lds
v_add_f32 v36, v36, v228
v_add_f32 v36, v36, v229
v_max3_f32 v34, v34, v232, v233
v_exp_f32 v232, v232
v_mfma_f32_32x32x16_bf16 v[128:143], a[0:3], v[64:67], v[128:143]
ds_read_b128 v[48:51], v28 offset:0
ds_read_b128 v[52:55], v28 offset:1024
ds_read_b128 v[56:59], v28 offset:2048
buffer_load_dwordx4 v16, s[44:47], s41 offen offset:2048 lds
v_exp_f32 v233, v233
v_cvt_pk_bf16_f32 v83, v230, v231
v_add_f32 v36, v36, v230
v_add_f32 v36, v36, v231
v_mfma_f32_32x32x16_bf16 v[144:159], a[0:3], v[68:71], v[144:159]
ds_read_b128 v[60:63], v28 offset:3072
s_waitcnt vmcnt(19)
ds_read_b64_tr_b16 a[16:17], v24 offset:8192
buffer_load_dwordx4 v17, s[44:47], s41 offen offset:3072 lds
v_max3_f32 v34, v34, v234, v235
v_exp_f32 v234, v234
v_exp_f32 v235, v235
v_mfma_f32_32x32x16_bf16 v[160:175], a[4:7], v[64:67], v[160:175]
ds_read_b64_tr_b16 a[18:19], v24 offset:9216
ds_read_b64_tr_b16 a[20:21], v25 offset:8192
ds_read_b64_tr_b16 a[22:23], v25 offset:9216
v_cvt_pk_bf16_f32 v84, v232, v233
v_add_f32 v36, v36, v232
v_add_f32 v36, v36, v233
ds_write_b128 v30, v[80:83] offset:16384
v_mfma_f32_32x32x16_bf16 v[176:191], a[4:7], v[68:71], v[176:191]
ds_read_b64_tr_b16 a[24:25], v24 offset:10240
ds_read_b64_tr_b16 a[26:27], v24 offset:11264
ds_read_b64_tr_b16 a[28:29], v25 offset:10240
v_max3_f32 v34, v34, v236, v237
v_exp_f32 v236, v236
v_exp_f32 v237, v237
v_mfma_f32_32x32x16_bf16 v[128:143], a[8:11], v[72:75], v[128:143]
ds_read_b64_tr_b16 a[30:31], v25 offset:11264
v_cvt_pk_bf16_f32 v85, v234, v235
v_add_f32 v36, v36, v234
v_add_f32 v36, v36, v235
v_max3_f32 v34, v34, v238, v239
v_exp_f32 v238, v238
v_mfma_f32_32x32x16_bf16 v[144:159], a[8:11], v[76:79], v[144:159]
v_exp_f32 v239, v239
v_cvt_pk_bf16_f32 v86, v236, v237
v_add_f32 v36, v36, v236
v_add_f32 v36, v36, v237
v_add_f32 v36, v36, v238
v_mfma_f32_32x32x16_bf16 v[160:175], a[12:15], v[72:75], v[160:175]
s_add_u32 m0, s40, 8192
s_mov_b32 s41, 49152
s_waitcnt lgkmcnt(0)
buffer_load_dwordx4 v10, s[24:27], s41 offen lds
v_cvt_pk_bf16_f32 v87, v238, v239
v_add_f32 v36, v36, v239
ds_write_b128 v30, v[84:87] offset:18432
v_mfma_f32_32x32x16_bf16 v[176:191], a[12:15], v[76:79], v[176:191]
buffer_load_dwordx4 v11, s[24:27], s41 offen offset:1024 lds
v_max3_f32 v35, v35, v240, v241
v_exp_f32 v240, v240
v_exp_f32 v241, v241
v_mfma_f32_32x32x16_bf16 v[128:143], a[16:19], v[48:51], v[128:143]
ds_read_b128 v[64:67], v28 offset:4096
ds_read_b128 v[68:71], v28 offset:5120
ds_read_b128 v[72:75], v28 offset:6144
buffer_load_dwordx4 v12, s[24:27], s41 offen offset:2048 lds
v_max3_f32 v35, v35, v242, v243
v_exp_f32 v242, v242
v_exp_f32 v243, v243
v_mfma_f32_32x32x16_bf16 v[144:159], a[16:19], v[52:55], v[144:159]
ds_read_b128 v[76:79], v28 offset:7168
s_waitcnt vmcnt(19)
ds_read_b64_tr_b16 a[0:1], v24 offset:12288
buffer_load_dwordx4 v13, s[24:27], s41 offen offset:3072 lds
v_cvt_pk_bf16_f32 v88, v240, v241
v_add_f32 v37, v37, v240
v_add_f32 v37, v37, v241
v_max3_f32 v35, v35, v244, v245
v_exp_f32 v244, v244
v_mfma_f32_32x32x16_bf16 v[160:175], a[20:23], v[48:51], v[160:175]
ds_read_b64_tr_b16 a[2:3], v24 offset:13312
ds_read_b64_tr_b16 a[4:5], v25 offset:12288
ds_read_b64_tr_b16 a[6:7], v25 offset:13312
v_exp_f32 v245, v245
v_cvt_pk_bf16_f32 v89, v242, v243
v_add_f32 v37, v37, v242
v_add_f32 v37, v37, v243
v_mfma_f32_32x32x16_bf16 v[176:191], a[20:23], v[52:55], v[176:191]
ds_read_b64_tr_b16 a[8:9], v24 offset:14336
ds_read_b64_tr_b16 a[10:11], v24 offset:15360
ds_read_b64_tr_b16 a[12:13], v25 offset:14336
v_max3_f32 v35, v35, v246, v247
v_exp_f32 v246, v246
v_exp_f32 v247, v247
v_mfma_f32_32x32x16_bf16 v[128:143], a[24:27], v[56:59], v[128:143]
ds_read_b64_tr_b16 a[14:15], v25 offset:15360
v_cvt_pk_bf16_f32 v90, v244, v245
v_add_f32 v37, v37, v244
v_add_f32 v37, v37, v245
v_max3_f32 v35, v35, v248, v249
v_exp_f32 v248, v248
v_mfma_f32_32x32x16_bf16 v[144:159], a[24:27], v[60:63], v[144:159]
v_exp_f32 v249, v249
v_cvt_pk_bf16_f32 v91, v246, v247
v_add_f32 v37, v37, v246
v_add_f32 v37, v37, v247
v_max3_f32 v35, v35, v250, v251
v_mfma_f32_32x32x16_bf16 v[160:175], a[28:31], v[56:59], v[160:175]
s_add_u32 m0, s40, 12288
s_mov_b32 s41, 114688
s_waitcnt lgkmcnt(0)
buffer_load_dwordx4 v10, s[24:27], s41 offen lds
v_exp_f32 v250, v250
v_exp_f32 v251, v251
v_cvt_pk_bf16_f32 v92, v248, v249
v_mfma_f32_32x32x16_bf16 v[176:191], a[28:31], v[60:63], v[176:191]
buffer_load_dwordx4 v11, s[24:27], s41 offen offset:1024 lds
v_add_f32 v37, v37, v248
v_add_f32 v37, v37, v249
ds_write_b128 v30, v[88:91] offset:17408
v_mfma_f32_32x32x16_bf16 v[128:143], a[0:3], v[64:67], v[128:143]
ds_read_b128 v[48:51], v28 offset:8192
ds_read_b128 v[52:55], v28 offset:9216
ds_read_b128 v[56:59], v28 offset:10240
buffer_load_dwordx4 v12, s[24:27], s41 offen offset:2048 lds
v_max3_f32 v35, v35, v252, v253
v_exp_f32 v252, v252
v_exp_f32 v253, v253
v_mfma_f32_32x32x16_bf16 v[144:159], a[0:3], v[68:71], v[144:159]
ds_read_b128 v[60:63], v28 offset:11264
s_waitcnt vmcnt(19)
ds_read_b64_tr_b16 a[16:17], v24 offset:16384
buffer_load_dwordx4 v13, s[24:27], s41 offen offset:3072 lds
v_cvt_pk_bf16_f32 v93, v250, v251
v_add_f32 v37, v37, v250
v_add_f32 v37, v37, v251
v_max3_f32 v35, v35, v254, v255
v_exp_f32 v254, v254
v_mfma_f32_32x32x16_bf16 v[160:175], a[4:7], v[64:67], v[160:175]
ds_read_b64_tr_b16 a[18:19], v24 offset:17408
ds_read_b64_tr_b16 a[20:21], v25 offset:16384
ds_read_b64_tr_b16 a[22:23], v25 offset:17408
v_exp_f32 v255, v255
v_cvt_pk_bf16_f32 v94, v252, v253
v_add_f32 v37, v37, v252
v_add_f32 v37, v37, v253
v_mfma_f32_32x32x16_bf16 v[176:191], a[4:7], v[68:71], v[176:191]
ds_read_b64_tr_b16 a[24:25], v24 offset:18432
ds_read_b64_tr_b16 a[26:27], v24 offset:19456
ds_read_b64_tr_b16 a[28:29], v25 offset:18432
v_add_f32 v37, v37, v254
v_cvt_pk_bf16_f32 v95, v254, v255
v_add_f32 v37, v37, v255
ds_write_b128 v30, v[92:95] offset:19456
v_mfma_f32_32x32x16_bf16 v[128:143], a[8:11], v[72:75], v[128:143]
ds_read_b64_tr_b16 a[30:31], v25 offset:19456
s_waitcnt vmcnt(16)
ds_read_b64_tr_b16 a[128:129], v26 offset:20480
ds_write_b32 v31, v34 offset:32768
ds_write_b32 v31, v36 offset:34816
v_mfma_f32_32x32x16_bf16 v[144:159], a[8:11], v[76:79], v[144:159]
ds_read_b64_tr_b16 a[130:131], v26 offset:21504
ds_read_b64_tr_b16 a[132:133], v27 offset:20480
ds_read_b64_tr_b16 a[134:135], v27 offset:21504
ds_write_b32 v31, v35 offset:33792
ds_write_b32 v31, v37 offset:35840
v_mfma_f32_32x32x16_bf16 v[160:175], a[12:15], v[72:75], v[160:175]
ds_read_b64_tr_b16 a[136:137], v26 offset:22528
ds_read_b64_tr_b16 a[138:139], v26 offset:23552
ds_read_b64_tr_b16 a[140:141], v27 offset:22528
s_add_u32 m0, s40, 16384
s_mov_b32 s41, 180224
s_waitcnt lgkmcnt(11)
buffer_load_dwordx4 v10, s[24:27], s41 offen lds
ds_read_b64_tr_b16 a[142:143], v27 offset:23552
v_mfma_f32_32x32x16_bf16 v[176:191], a[12:15], v[76:79], v[176:191]
buffer_load_dwordx4 v11, s[24:27], s41 offen offset:1024 lds
v_mfma_f32_32x32x16_bf16 v[128:143], a[16:19], v[48:51], v[128:143]
ds_read_b128 v[64:67], v28 offset:12288
ds_read_b128 v[68:71], v28 offset:13312
ds_read_b128 v[72:75], v28 offset:14336
buffer_load_dwordx4 v12, s[24:27], s41 offen offset:2048 lds
v_mfma_f32_32x32x16_bf16 v[144:159], a[16:19], v[52:55], v[144:159]
ds_read_b128 v[76:79], v28 offset:15360
s_waitcnt vmcnt(15)
ds_read_b64_tr_b16 a[0:1], v24 offset:0
buffer_load_dwordx4 v13, s[24:27], s41 offen offset:3072 lds
v_mfma_f32_32x32x16_bf16 v[160:175], a[20:23], v[48:51], v[160:175]
ds_read_b64_tr_b16 a[2:3], v24 offset:1024
ds_read_b64_tr_b16 a[4:5], v25 offset:0
ds_read_b64_tr_b16 a[6:7], v25 offset:1024
s_add_u32 m0, s40, 20480
s_mov_b32 s41, 245760
s_waitcnt lgkmcnt(8)
buffer_load_dwordx4 v10, s[24:27], s41 offen lds
v_mfma_f32_32x32x16_bf16 v[176:191], a[20:23], v[52:55], v[176:191]
ds_read_b64_tr_b16 a[8:9], v24 offset:2048
ds_read_b64_tr_b16 a[10:11], v24 offset:3072
ds_read_b64_tr_b16 a[12:13], v25 offset:2048
buffer_load_dwordx4 v11, s[24:27], s41 offen offset:1024 lds
v_mfma_f32_32x32x16_bf16 v[128:143], a[24:27], v[56:59], v[128:143]
ds_read_b64_tr_b16 a[14:15], v25 offset:3072
s_waitcnt vmcnt(14)
ds_read_b64_tr_b16 a[144:145], v26 offset:4096
buffer_load_dwordx4 v12, s[24:27], s41 offen offset:2048 lds
v_mfma_f32_32x32x16_bf16 v[144:159], a[24:27], v[60:63], v[144:159]
ds_read_b64_tr_b16 a[146:147], v26 offset:5120
ds_read_b64_tr_b16 a[148:149], v27 offset:4096
ds_read_b64_tr_b16 a[150:151], v27 offset:5120
buffer_load_dwordx4 v13, s[24:27], s41 offen offset:3072 lds
v_mfma_f32_32x32x16_bf16 v[160:175], a[28:31], v[56:59], v[160:175]
ds_read_b64_tr_b16 a[152:153], v26 offset:6144
ds_read_b64_tr_b16 a[154:155], v26 offset:7168
ds_read_b64_tr_b16 a[156:157], v27 offset:6144
s_add_u32 s50, s7, 1
s_and_b32 s50, s50, 7
s_mul_i32 s50, s50, 28672
s_add_u32 m0, s40, 0
s_add_u32 s41, s50, 0
s_waitcnt lgkmcnt(7)
buffer_load_dwordx4 v14, s[28:31], s41 offen lds
ds_read_b64_tr_b16 a[158:159], v27 offset:7168
v_mfma_f32_32x32x16_bf16 v[176:191], a[28:31], v[60:63], v[176:191]
buffer_load_dwordx4 v15, s[28:31], s41 offen offset:1024 lds
s_waitcnt lgkmcnt(0)
s_cmp_lg_u32 s9, 0
s_cbranch_scc1 L_nn3A
L_nn2A:
s_nop 1
v_readfirstlane_b32 s10, v40
s_cmp_lg_u32 s10, 0
s_cbranch_scc1 L_nn4A
s_sleep 2
global_load_dwordx2 v[40:41], v42, s[38:39] sc1
s_waitcnt vmcnt(0)
s_branch L_nn2A
L_nn4A:
v_mov_b32 v42, 135168
ds_write_b64 v42, v[40:41]
L_nn3A:
s_waitcnt lgkmcnt(0)
s_barrier
v_mfma_f32_32x32x16_bf16 v[128:143], a[0:3], v[64:67], v[128:143]
ds_read_b128 v[48:51], v28 offset:16384
ds_read_b128 v[52:55], v28 offset:17408
ds_read_b128 v[56:59], v28 offset:18432
buffer_load_dwordx4 v16, s[28:31], s41 offen offset:2048 lds
v_mfma_f32_32x32x16_bf16 v[144:159], a[0:3], v[68:71], v[144:159]
ds_read_b128 v[60:63], v28 offset:19456
s_waitcnt vmcnt(15)
ds_read_b64_tr_b16 a[16:17], v24 offset:8192
buffer_load_dwordx4 v17, s[28:31], s41 offen offset:3072 lds
v_mfma_f32_32x32x16_bf16 v[160:175], a[4:7], v[64:67], v[160:175]
ds_read_b64_tr_b16 a[18:19], v24 offset:9216
ds_read_b64_tr_b16 a[20:21], v25 offset:8192
ds_read_b64_tr_b16 a[22:23], v25 offset:9216
s_add_u32 s50, s7, 2
s_and_b32 s50, s50, 7
s_mul_i32 s50, s50, 28672
s_add_u32 m0, s40, 4096
s_add_u32 s41, s50, 0
buffer_load_dwordx4 v14, s[28:31], s41 offen lds
ds_read_b128 v[80:83], v32 offset:32768
ds_read_b128 v[84:87], v32 offset:32784
v_mfma_f32_32x32x16_bf16 v[176:191], a[4:7], v[68:71], v[176:191]
ds_read_b64_tr_b16 a[24:25], v24 offset:10240
ds_read_b64_tr_b16 a[26:27], v24 offset:11264
ds_read_b64_tr_b16 a[28:29], v25 offset:10240
buffer_load_dwordx4 v15, s[28:31], s41 offen offset:1024 lds
ds_read_b128 v[88:91], v32 offset:33792
ds_read_b128 v[92:95], v32 offset:33808
v_mfma_f32_32x32x16_bf16 v[128:143], a[8:11], v[72:75], v[128:143]
ds_read_b64_tr_b16 a[30:31], v25 offset:11264
buffer_load_dwordx4 v16, s[28:31], s41 offen offset:2048 lds
ds_read_b128 v[192:195], v32 offset:34816
ds_read_b128 v[196:199], v32 offset:34832
v_mfma_f32_32x32x16_bf16 v[144:159], a[8:11], v[76:79], v[144:159]
buffer_load_dwordx4 v17, s[28:31], s41 offen offset:3072 lds
ds_read_b128 v[200:203], v32 offset:35840
ds_read_b128 v[204:207], v32 offset:35856
v_mfma_f32_32x32x16_bf16 v[160:175], a[12:15], v[72:75], v[160:175]
s_add_u32 s50, s7, 3
s_and_b32 s50, s50, 7
s_mul_i32 s50, s50, 28672
s_add_u32 m0, s40, 8192
s_add_u32 s41, s50, 0
s_waitcnt lgkmcnt(4)
buffer_load_dwordx4 v14, s[28:31], s41 offen lds
v_max3_f32 v34, v80, v81, v82
v_max3_f32 v34, v34, v83, v84
v_max3_f32 v34, v34, v85, v86
v_max_f32 v34, v34, v87
v_mfma_f32_32x32x16_bf16 v[176:191], a[12:15], v[76:79], v[176:191]
buffer_load_dwordx4 v15, s[28:31], s41 offen offset:1024 lds
v_max3_f32 v35, v88, v89, v90
v_max3_f32 v35, v35, v91, v92
v_max3_f32 v35, v35, v93, v94
v_max_f32 v35, v35, v95
v_mfma_f32_32x32x16_bf16 v[128:143], a[16:19], v[48:51], v[128:143]
ds_read_b128 v[64:67], v28 offset:20480
ds_read_b128 v[68:71], v28 offset:21504
ds_read_b128 v[72:75], v28 offset:22528
buffer_load_dwordx4 v16, s[28:31], s41 offen offset:2048 lds
s_waitcnt lgkmcnt(6)
v_add_f32 v36, v192, v193
v_add_f32 v36, v36, v194
v_add_f32 v36, v36, v195
s_waitcnt lgkmcnt(5)
v_add_f32 v36, v36, v196
v_mfma_f32_32x32x16_bf16 v[144:159], a[16:19], v[52:55], v[144:159]
ds_read_b128 v[76:79], v28 offset:23552
s_waitcnt vmcnt(19)
ds_read_b64_tr_b16 a[0:1], v24 offset:12288
buffer_load_dwordx4 v17, s[28:31], s41 offen offset:3072 lds
v_add_f32 v36, v36, v197
v_add_f32 v36, v36, v198
v_add_f32 v36, v36, v199
v_rcp_f32 v36, v36
v_mfma_f32_32x32x16_bf16 v[160:175], a[20:23], v[48:51], v[160:175]
ds_read_b64_tr_b16 a[2:3], v24 offset:13312
ds_read_b64_tr_b16 a[4:5], v25 offset:12288
ds_read_b64_tr_b16 a[6:7], v25 offset:13312
s_waitcnt lgkmcnt(9)
v_add_f32 v37, v200, v201
v_add_f32 v37, v37, v202
v_add_f32 v37, v37, v203
s_waitcnt lgkmcnt(8)
v_add_f32 v37, v37, v204
v_mfma_f32_32x32x16_bf16 v[176:191], a[20:23], v[52:55], v[176:191]
ds_read_b64_tr_b16 a[8:9], v24 offset:14336
ds_read_b64_tr_b16 a[10:11], v24 offset:15360
ds_read_b64_tr_b16 a[12:13], v25 offset:14336
v_add_f32 v37, v37, v205
v_add_f32 v37, v37, v206
v_add_f32 v37, v37, v207
v_rcp_f32 v37, v37
v_mfma_f32_32x32x16_bf16 v[128:143], a[24:27], v[56:59], v[128:143]
ds_read_b64_tr_b16 a[14:15], v25 offset:15360
v_mfma_f32_32x32x16_bf16 v[144:159], a[24:27], v[60:63], v[144:159]
v_mfma_f32_32x32x16_bf16 v[160:175], a[28:31], v[56:59], v[160:175]
s_add_u32 s50, s7, 4
s_and_b32 s50, s50, 7
s_mul_i32 s50, s50, 28672
s_add_u32 m0, s40, 12288
s_add_u32 s41, s50, 0
s_waitcnt lgkmcnt(0)
buffer_load_dwordx4 v14, s[28:31], s41 offen lds
v_mfma_f32_32x32x16_bf16 v[176:191], a[28:31], v[60:63], v[176:191]
buffer_load_dwordx4 v15, s[28:31], s41 offen offset:1024 lds
v_mov_b32 v42, 135168
ds_read_b64 v[40:41], v42
s_waitcnt lgkmcnt(0)
v_readfirstlane_b32 s100, v40
v_readfirstlane_b32 s101, v41
s_cmp_lg_u32 s43, 0
s_cbranch_scc1 L_safeA
v_max_f32 v38, |v34|, |v35|
v_mov_b32 v39, 0x42700000
v_cmp_nle_f32 vcc, v38, v39
s_nop 1
s_cbranch_vccz L_safeA
s_nop 7
s_nop 7
v_sub_f32 v96, 0, v34
v_sub_f32 v97, 0, v34
v_sub_f32 v98, 0, v34
v_sub_f32 v99, 0, v34
v_sub_f32 v100, 0, v34
v_sub_f32 v101, 0, v34
v_sub_f32 v102, 0, v34
v_sub_f32 v103, 0, v34
v_sub_f32 v104, 0, v34
v_sub_f32 v105, 0, v34
v_sub_f32 v106, 0, v34
v_sub_f32 v107, 0, v34
v_sub_f32 v108, 0, v34
v_sub_f32 v109, 0, v34
v_sub_f32 v110, 0, v34
v_sub_f32 v111, 0, v34
v_sub_f32 v112, 0, v35
v_sub_f32 v113, 0, v35
v_sub_f32 v114, 0, v35
v_sub_f32 v115, 0, v35
v_sub_f32 v116, 0, v35
v_sub_f32 v117, 0, v35
v_sub_f32 v118, 0, v35
v_sub_f32 v119, 0, v35
v_sub_f32 v120, 0, v35
v_sub_f32 v121, 0, v35
v_sub_f32 v122, 0, v35
v_sub_f32 v123, 0, v35
v_sub_f32 v124, 0, v35
v_sub_f32 v125, 0, v35
v_sub_f32 v126, 0, v35
v_sub_f32 v127, 0, v35
s_mov_b32 s43, 1
s_branch L_restartA
L_safeA:
s_nop 1
v_mfma_f32_32x32x16_bf16 v[128:143], a[0:3], v[64:67], v[128:143]
ds_read_b128 v[48:51], v28 offset:24576
ds_read_b128 v[52:55], v28 offset:25600
ds_read_b128 v[56:59], v28 offset:26624
buffer_load_dwordx4 v16, s[28:31], s41 offen offset:2048 lds
v_mfma_f32_32x32x16_bf16 v[144:159], a[0:3], v[68:71], v[144:159]
ds_read_b128 v[60:63], v28 offset:27648
s_waitcnt vmcnt(19)
ds_read_b64_tr_b16 a[16:17], v24 offset:16384
buffer_load_dwordx4 v17, s[28:31], s41 offen offset:3072 lds
v_mfma_f32_32x32x16_bf16 v[160:175], a[4:7], v[64:67], v[160:175]
ds_read_b64_tr_b16 a[18:19], v24 offset:17408
ds_read_b64_tr_b16 a[20:21], v25 offset:16384
ds_read_b64_tr_b16 a[22:23], v25 offset:17408
v_mfma_f32_32x32x16_bf16 v[176:191], a[4:7], v[68:71], v[176:191]
ds_read_b64_tr_b16 a[24:25], v24 offset:18432
ds_read_b64_tr_b16 a[26:27], v24 offset:19456
ds_read_b64_tr_b16 a[28:29], v25 offset:18432
v_mfma_f32_32x32x16_bf16 v[128:143], a[8:11], v[72:75], v[128:143]
ds_read_b64_tr_b16 a[30:31], v25 offset:19456
v_mfma_f32_32x32x16_bf16 v[144:159], a[8:11], v[76:79], v[144:159]
v_mfma_f32_32x32x16_bf16 v[160:175], a[12:15], v[72:75], v[160:175]
s_add_u32 s50, s7, 5
s_and_b32 s50, s50, 7
s_mul_i32 s50, s50, 28672
s_add_u32 m0, s40, 16384
s_add_u32 s41, s50, 0
s_waitcnt lgkmcnt(0)
buffer_load_dwordx4 v14, s[28:31], s41 offen lds
v_mfma_f32_32x32x16_bf16 v[176:191], a[12:15], v[76:79], v[176:191]
buffer_load_dwordx4 v15, s[28:31], s41 offen offset:1024 lds
s_waitcnt lgkmcnt(0)
s_barrier
v_mfma_f32_32x32x16_bf16 v[128:143], a[16:19], v[48:51], v[128:143]
ds_read_b128 v[64:67], v28 offset:28672
ds_read_b128 v[68:71], v28 offset:29696
ds_read_b128 v[72:75], v28 offset:30720
buffer_load_dwordx4 v16, s[28:31], s41 offen offset:2048 lds
v_mfma_f32_32x32x16_bf16 v[144:159], a[16:19], v[52:55], v[144:159]
ds_read_b128 v[76:79], v28 offset:31744
s_waitcnt vmcnt(19)
ds_read_b64_tr_b16 v[192:193], v24 offset:20480
buffer_load_dwordx4 v17, s[28:31], s41 offen offset:3072 lds
v_mfma_f32_32x32x16_bf16 v[160:175], a[20:23], v[48:51], v[160:175]
ds_read_b64_tr_b16 v[194:195], v24 offset:21504
ds_read_b64_tr_b16 v[196:197], v25 offset:20480
ds_read_b64_tr_b16 v[198:199], v25 offset:21504
v_mfma_f32_32x32x16_bf16 v[176:191], a[20:23], v[52:55], v[176:191]
ds_read_b64_tr_b16 v[200:201], v24 offset:22528
ds_read_b64_tr_b16 v[202:203], v24 offset:23552
ds_read_b64_tr_b16 v[204:205], v25 offset:22528
v_mfma_f32_32x32x16_bf16 v[128:143], a[24:27], v[56:59], v[128:143]
ds_read_b64_tr_b16 v[206:207], v25 offset:23552
s_waitcnt vmcnt(16)
ds_read_b64_tr_b16 v[208:209], v26 offset:0
v_mfma_f32_32x32x16_bf16 v[144:159], a[24:27], v[60:63], v[144:159]
ds_read_b64_tr_b16 v[210:211], v26 offset:1024
ds_read_b64_tr_b16 v[212:213], v27 offset:0
ds_read_b64_tr_b16 v[214:215], v27 offset:1024
v_mfma_f32_32x32x16_bf16 v[160:175], a[28:31], v[56:59], v[160:175]
ds_read_b64_tr_b16 v[216:217], v26 offset:2048
ds_read_b64_tr_b16 v[218:219], v26 offset:3072
ds_read_b64_tr_b16 v[220:221], v27 offset:2048
s_add_u32 s50, s7, 6
s_and_b32 s50, s50, 7
s_mul_i32 s50, s50, 28672
s_add_u32 m0, s40, 20480
s_add_u32 s41, s50, 0
s_waitcnt lgkmcnt(7)
buffer_load_dwordx4 v14, s[28:31], s41 offen lds
ds_read_b64_tr_b16 v[222:223], v27 offset:3072
v_mfma_f32_32x32x16_bf16 v[176:191], a[28:31], v[60:63], v[176:191]
buffer_load_dwordx4 v15, s[28:31], s41 offen offset:1024 lds
s_lshl_b32 s10, s9, 1
s_add_u32 s10, s10, 8
s_sub_u32 s10, s10, s7
s_and_b32 s10, s10, 7
s_lshl_b32 s10, s10, 12
v_add_u32 v44, s10, v28
s_lshl_b32 s10, s9, 1
s_add_u32 s10, s10, 9
s_sub_u32 s10, s10, s7
s_and_b32 s10, s10, 7
s_lshl_b32 s10, s10, 12
v_add_u32 v45, s10, v28
v_mfma_f32_32x32x16_bf16 v[128:143], v[192:195], v[64:67], v[128:143]
s_waitcnt vmcnt(14)
ds_read_b64_tr_b16 v[224:225], v26 offset:4096
ds_read_b64_tr_b16 v[226:227], v26 offset:5120
buffer_load_dwordx4 v16, s[28:31], s41 offen offset:2048 lds
v_mfma_f32_32x32x16_bf16 v[128:143], v[200:203], v[72:75], v[128:143]
ds_read_b64_tr_b16 v[228:229], v27 offset:4096
ds_read_b64_tr_b16 v[230:231], v27 offset:5120
ds_read_b64_tr_b16 v[232:233], v26 offset:6144
buffer_load_dwordx4 v17, s[28:31], s41 offen offset:3072 lds
v_mfma_f32_32x32x16_bf16 v[144:159], v[192:195], v[68:71], v[144:159]
ds_read_b64_tr_b16 v[234:235], v26 offset:7168
ds_read_b64_tr_b16 v[236:237], v27 offset:6144
ds_read_b64_tr_b16 v[238:239], v27 offset:7168
s_add_u32 s50, s7, 7
s_and_b32 s50, s50, 7
s_mul_i32 s50, s50, 28672
s_add_u32 m0, s40, 0
s_add_u32 s41, s50, 0
s_waitcnt lgkmcnt(8)
buffer_load_dwordx4 v14, s[28:31], s41 offen lds
v_mfma_f32_32x32x16_bf16 v[144:159], v[200:203], v[76:79], v[144:159]
buffer_load_dwordx4 v15, s[28:31], s41 offen offset:1024 lds
v_mfma_f32_32x32x16_bf16 v[160:175], v[196:199], v[64:67], v[160:175]
buffer_load_dwordx4 v16, s[28:31], s41 offen offset:2048 lds
v_mul_f32 v128, v36, v128
v_mul_f32 v129, v36, v129
v_mul_f32 v130, v36, v130
v_mul_f32 v131, v36, v131
v_mul_f32 v132, v36, v132
v_mul_f32 v133, v36, v133
v_mfma_f32_32x32x16_bf16 v[160:175], v[204:207], v[72:75], v[160:175]
buffer_load_dwordx4 v17, s[28:31], s41 offen offset:3072 lds
v_mul_f32 v134, v36, v134
v_mul_f32 v135, v36, v135
v_cvt_pk_bf16_f32 v80, v128, v129
v_cvt_pk_bf16_f32 v81, v130, v131
v_cvt_pk_bf16_f32 v82, v132, v133
v_cvt_pk_bf16_f32 v83, v134, v135
v_mfma_f32_32x32x16_bf16 v[176:191], v[196:199], v[68:71], v[176:191]
s_add_u32 s50, s7, 1
s_and_b32 s50, s50, 7
s_mul_i32 s50, s50, 28672
s_add_u32 m0, s40, 4096
s_add_u32 s41, s50, 128
s_waitcnt lgkmcnt(0)
buffer_load_dwordx4 v14, s[44:47], s41 offen lds
ds_write_b128 v44, v[80:83] offset:32768
v_mul_f32 v136, v36, v136
v_mul_f32 v137, v36, v137
v_mul_f32 v138, v36, v138
v_mul_f32 v139, v36, v139
v_mul_f32 v140, v36, v140
v_mfma_f32_32x32x16_bf16 v[176:191], v[204:207], v[76:79], v[176:191]
buffer_load_dwordx4 v15, s[44:47], s41 offen offset:1024 lds
v_mul_f32 v141, v36, v141
v_mul_f32 v142, v36, v142
v_mul_f32 v143, v36, v143
v_cvt_pk_bf16_f32 v84, v136, v137
v_cvt_pk_bf16_f32 v85, v138, v139
v_cvt_pk_bf16_f32 v86, v140, v141
v_cvt_pk_bf16_f32 v87, v142, v143
ds_write_b128 v44, v[84:87] offset:34816
v_mul_f32 v144, v37, v144
v_mul_f32 v145, v37, v145
v_mul_f32 v146, v37, v146
v_mul_f32 v147, v37, v147
v_mul_f32 v148, v37, v148
v_mul_f32 v149, v37, v149
v_mul_f32 v150, v37, v150
v_mul_f32 v151, v37, v151
v_cvt_pk_bf16_f32 v88, v144, v145
v_cvt_pk_bf16_f32 v89, v146, v147
v_cvt_pk_bf16_f32 v90, v148, v149
v_cvt_pk_bf16_f32 v91, v150, v151
ds_write_b128 v44, v[88:91] offset:33792
v_mul_f32 v152, v37, v152
v_mul_f32 v153, v37, v153
v_mul_f32 v154, v37, v154
v_mul_f32 v155, v37, v155
v_mul_f32 v156, v37, v156
v_mul_f32 v157, v37, v157
v_mul_f32 v158, v37, v158
v_mul_f32 v159, v37, v159
v_cvt_pk_bf16_f32 v92, v152, v153
buffer_load_dwordx4 v16, s[44:47], s41 offen offset:2048 lds
v_cvt_pk_bf16_f32 v93, v154, v155
v_cvt_pk_bf16_f32 v94, v156, v157
v_cvt_pk_bf16_f32 v95, v158, v159
ds_write_b128 v44, v[92:95] offset:35840
v_mul_f32 v160, v36, v160
v_mul_f32 v161, v36, v161
v_mul_f32 v162, v36, v162
v_mul_f32 v163, v36, v163
v_mul_f32 v164, v36, v164
v_mul_f32 v165, v36, v165
v_mul_f32 v166, v36, v166
v_mul_f32 v167, v36, v167
v_cvt_pk_bf16_f32 v80, v160, v161
v_cvt_pk_bf16_f32 v81, v162, v163
v_cvt_pk_bf16_f32 v82, v164, v165
v_cvt_pk_bf16_f32 v83, v166, v167
ds_write_b128 v45, v[80:83] offset:32768
v_mul_f32 v168, v36, v168
v_mul_f32 v169, v36, v169
v_mul_f32 v170, v36, v170
v_mul_f32 v171, v36, v171
v_mul_f32 v172, v36, v172
v_mul_f32 v173, v36, v173
v_mul_f32 v174, v36, v174
buffer_load_dwordx4 v17, s[44:47], s41 offen offset:3072 lds
v_mul_f32 v175, v36, v175
v_cvt_pk_bf16_f32 v84, v168, v169
v_cvt_pk_bf16_f32 v85, v170, v171
v_cvt_pk_bf16_f32 v86, v172, v173
v_cvt_pk_bf16_f32 v87, v174, v175
ds_write_b128 v45, v[84:87] offset:34816
v_mul_f32 v176, v37, v176
v_mul_f32 v177, v37, v177
v_mul_f32 v178, v37, v178
v_mul_f32 v179, v37, v179
v_mul_f32 v180, v37, v180
v_mul_f32 v181, v37, v181
v_mul_f32 v182, v37, v182
v_mul_f32 v183, v37, v183
v_cvt_pk_bf16_f32 v88, v176, v177
v_cvt_pk_bf16_f32 v89, v178, v179
v_cvt_pk_bf16_f32 v90, v180, v181
v_cvt_pk_bf16_f32 v91, v182, v183
ds_write_b128 v45, v[88:91] offset:33792
v_mul_f32 v184, v37, v184
v_mul_f32 v185, v37, v185
v_mul_f32 v186, v37, v186
v_mul_f32 v187, v37, v187
v_mul_f32 v188, v37, v188
v_mul_f32 v189, v37, v189
v_mul_f32 v190, v37, v190
v_mul_f32 v191, v37, v191
v_cvt_pk_bf16_f32 v92, v184, v185
v_cvt_pk_bf16_f32 v93, v186, v187
v_cvt_pk_bf16_f32 v94, v188, v189
v_cvt_pk_bf16_f32 v95, v190, v191
ds_write_b128 v45, v[92:95] offset:35840
s_waitcnt lgkmcnt(0)
s_barrier
ds_read_b128 a[0:3], v28 offset:32768
ds_read_b128 a[4:7], v28 offset:33792
ds_read_b128 a[8:11], v28 offset:34816
ds_read_b128 a[12:15], v28 offset:35840
s_waitcnt lgkmcnt(3)
v_mfma_f32_32x32x16_bf16 v[128:143], a[128:131], a[0:3], 0
ds_read_b128 a[16:19], v28 offset:36864
ds_read_b128 a[20:23], v28 offset:37888
ds_read_b128 a[24:27], v28 offset:38912
s_waitcnt lgkmcnt(5)
v_mfma_f32_32x32x16_bf16 v[144:159], a[128:131], a[4:7], 0
ds_read_b128 a[28:31], v28 offset:39936
s_waitcnt vmcnt(20)
ds_read_b64_tr_b16 v[192:193], v26 offset:8192
v_mfma_f32_32x32x16_bf16 v[160:175], a[132:135], a[0:3], 0
ds_read_b64_tr_b16 v[194:195], v26 offset:9216
ds_read_b64_tr_b16 v[196:197], v27 offset:8192
ds_read_b64_tr_b16 v[198:199], v27 offset:9216
v_mfma_f32_32x32x16_bf16 v[176:191], a[132:135], a[4:7], 0
ds_read_b64_tr_b16 v[200:201], v26 offset:10240
ds_read_b64_tr_b16 v[202:203], v26 offset:11264
ds_read_b64_tr_b16 v[204:205], v27 offset:10240
s_waitcnt lgkmcnt(12)
v_mfma_f32_32x32x16_bf16 v[128:143], a[136:139], a[8:11], v[128:143]
ds_read_b64_tr_b16 v[206:207], v27 offset:11264
s_waitcnt lgkmcnt(12)
v_mfma_f32_32x32x16_bf16 v[144:159], a[136:139], a[12:15], v[144:159]
v_mfma_f32_32x32x16_bf16 v[160:175], a[140:143], a[8:11], v[160:175]
s_add_u32 s50, s7, 2
s_and_b32 s50, s50, 7
s_mul_i32 s50, s50, 28672
s_add_u32 m0, s40, 8192
s_add_u32 s41, s50, 128
s_waitcnt lgkmcnt(0)
buffer_load_dwordx4 v14, s[44:47], s41 offen lds
v_mfma_f32_32x32x16_bf16 v[176:191], a[140:143], a[12:15], v[176:191]
buffer_load_dwordx4 v15, s[44:47], s41 offen offset:1024 lds
v_mfma_f32_32x32x16_bf16 v[128:143], v[208:211], a[16:19], v[128:143]
ds_read_b128 a[32:35], v28 offset:40960
ds_read_b128 a[36:39], v28 offset:41984
ds_read_b128 a[40:43], v28 offset:43008
buffer_load_dwordx4 v16, s[44:47], s41 offen offset:2048 lds
v_mfma_f32_32x32x16_bf16 v[144:159], v[208:211], a[20:23], v[144:159]
ds_read_b128 a[44:47], v28 offset:44032
s_waitcnt vmcnt(19)
ds_read_b64_tr_b16 v[240:241], v26 offset:12288
buffer_load_dwordx4 v17, s[44:47], s41 offen offset:3072 lds
v_mfma_f32_32x32x16_bf16 v[160:175], v[212:215], a[16:19], v[160:175]
ds_read_b64_tr_b16 v[242:243], v26 offset:13312
ds_read_b64_tr_b16 v[244:245], v27 offset:12288
ds_read_b64_tr_b16 v[246:247], v27 offset:13312
v_mfma_f32_32x32x16_bf16 v[176:191], v[212:215], a[20:23], v[176:191]
ds_read_b64_tr_b16 v[248:249], v26 offset:14336
ds_read_b64_tr_b16 v[250:251], v26 offset:15360
ds_read_b64_tr_b16 v[252:253], v27 offset:14336
v_mfma_f32_32x32x16_bf16 v[128:143], v[216:219], a[24:27], v[128:143]
ds_read_b64_tr_b16 v[254:255], v27 offset:15360
v_mfma_f32_32x32x16_bf16 v[144:159], v[216:219], a[28:31], v[144:159]
v_mfma_f32_32x32x16_bf16 v[160:175], v[220:223], a[24:27], v[160:175]
s_add_u32 s50, s7, 3
s_and_b32 s50, s50, 7
s_mul_i32 s50, s50, 28672
s_add_u32 m0, s40, 12288
s_add_u32 s41, s50, 128
s_waitcnt lgkmcnt(0)
buffer_load_dwordx4 v14, s[44:47], s41 offen lds
v_mfma_f32_32x32x16_bf16 v[176:191], v[220:223], a[28:31], v[176:191]
buffer_load_dwordx4 v15, s[44:47], s41 offen offset:1024 lds
v_mfma_f32_32x32x16_bf16 v[128:143], v[224:227], a[32:35], v[128:143]
ds_read_b128 a[48:51], v28 offset:45056
ds_read_b128 a[52:55], v28 offset:46080
ds_read_b128 a[56:59], v28 offset:47104
buffer_load_dwordx4 v16, s[44:47], s41 offen offset:2048 lds
v_mfma_f32_32x32x16_bf16 v[144:159], v[224:227], a[36:39], v[144:159]
ds_read_b128 a[60:63], v28 offset:48128
s_waitcnt vmcnt(19)
ds_read_b64_tr_b16 v[208:209], v26 offset:16384
buffer_load_dwordx4 v17, s[44:47], s41 offen offset:3072 lds
v_mfma_f32_32x32x16_bf16 v[160:175], v[228:231], a[32:35], v[160:175]
ds_read_b64_tr_b16 v[210:211], v26 offset:17408
ds_read_b64_tr_b16 v[212:213], v27 offset:16384
ds_read_b64_tr_b16 v[214:215], v27 offset:17408
v_mfma_f32_32x32x16_bf16 v[176:191], v[228:231], a[36:39], v[176:191]
ds_read_b64_tr_b16 v[216:217], v26 offset:18432
ds_read_b64_tr_b16 v[218:219], v26 offset:19456
ds_read_b64_tr_b16 v[220:221], v27 offset:18432
v_mfma_f32_32x32x16_bf16 v[128:143], v[232:235], a[40:43], v[128:143]
ds_read_b64_tr_b16 v[222:223], v27 offset:19456
v_mfma_f32_32x32x16_bf16 v[144:159], v[232:235], a[44:47], v[144:159]
v_mfma_f32_32x32x16_bf16 v[160:175], v[236:239], a[40:43], v[160:175]
s_add_u32 s50, s7, 4
s_and_b32 s50, s50, 7
s_mul_i32 s50, s50, 28672
s_add_u32 m0, s40, 16384
s_add_u32 s41, s50, 128
s_waitcnt lgkmcnt(0)
buffer_load_dwordx4 v14, s[44:47], s41 offen lds
v_mfma_f32_32x32x16_bf16 v[176:191], v[236:239], a[44:47], v[176:191]
buffer_load_dwordx4 v15, s[44:47], s41 offen offset:1024 lds
v_mfma_f32_32x32x16_bf16 v[128:143], v[192:195], a[48:51], v[128:143]
ds_read_b128 a[64:67], v28 offset:49152
ds_read_b128 a[68:71], v28 offset:50176
ds_read_b128 a[72:75], v28 offset:51200
buffer_load_dwordx4 v16, s[44:47], s41 offen offset:2048 lds
v_mfma_f32_32x32x16_bf16 v[144:159], v[192:195], a[52:55], v[144:159]
ds_read_b128 a[76:79], v28 offset:52224
s_waitcnt vmcnt(19)
ds_read_b64_tr_b16 v[224:225], v26 offset:20480
buffer_load_dwordx4 v17, s[44:47], s41 offen offset:3072 lds
v_mfma_f32_32x32x16_bf16 v[160:175], v[196:199], a[48:51], v[160:175]
ds_read_b64_tr_b16 v[226:227], v26 offset:21504
ds_read_b64_tr_b16 v[228:229], v27 offset:20480
ds_read_b64_tr_b16 v[230:231], v27 offset:21504
v_mfma_f32_32x32x16_bf16 v[176:191], v[196:199], a[52:55], v[176:191]
ds_read_b64_tr_b16 v[232:233], v26 offset:22528
ds_read_b64_tr_b16 v[234:235], v26 offset:23552
ds_read_b64_tr_b16 v[236:237], v27 offset:22528
v_mfma_f32_32x32x16_bf16 v[128:143], v[200:203], a[56:59], v[128:143]
ds_read_b64_tr_b16 v[238:239], v27 offset:23552
v_mfma_f32_32x32x16_bf16 v[144:159], v[200:203], a[60:63], v[144:159]
v_mfma_f32_32x32x16_bf16 v[160:175], v[204:207], a[56:59], v[160:175]
s_add_u32 s50, s7, 5
s_and_b32 s50, s50, 7
s_mul_i32 s50, s50, 28672
s_add_u32 m0, s40, 20480
s_add_u32 s41, s50, 128
s_waitcnt lgkmcnt(0)
buffer_load_dwordx4 v14, s[44:47], s41 offen lds
v_mfma_f32_32x32x16_bf16 v[176:191], v[204:207], a[60:63], v[176:191]
buffer_load_dwordx4 v15, s[44:47], s41 offen offset:1024 lds
v_mfma_f32_32x32x16_bf16 v[128:143], v[240:243], a[64:67], v[128:143]
ds_read_b128 a[80:83], v28 offset:53248
ds_read_b128 a[84:87], v28 offset:54272
ds_read_b128 a[88:91], v28 offset:55296
buffer_load_dwordx4 v16, s[44:47], s41 offen offset:2048 lds
v_mfma_f32_32x32x16_bf16 v[144:159], v[240:243], a[68:71], v[144:159]
ds_read_b128 a[92:95], v28 offset:56320
s_waitcnt vmcnt(19)
ds_read_b64_tr_b16 v[192:193], v26 offset:0
buffer_load_dwordx4 v17, s[44:47], s41 offen offset:3072 lds
v_mfma_f32_32x32x16_bf16 v[160:175], v[244:247], a[64:67], v[160:175]
ds_read_b64_tr_b16 v[194:195], v26 offset:1024
ds_read_b64_tr_b16 v[196:197], v27 offset:0
ds_read_b64_tr_b16 v[198:199], v27 offset:1024
v_mfma_f32_32x32x16_bf16 v[176:191], v[244:247], a[68:71], v[176:191]
ds_read_b64_tr_b16 v[200:201], v26 offset:2048
ds_read_b64_tr_b16 v[202:203], v26 offset:3072
ds_read_b64_tr_b16 v[204:205], v27 offset:2048
v_mfma_f32_32x32x16_bf16 v[128:143], v[248:251], a[72:75], v[128:143]
ds_read_b64_tr_b16 v[206:207], v27 offset:3072
v_mfma_f32_32x32x16_bf16 v[144:159], v[248:251], a[76:79], v[144:159]
v_mfma_f32_32x32x16_bf16 v[160:175], v[252:255], a[72:75], v[160:175]
s_add_u32 s50, s7, 6
s_and_b32 s50, s50, 7
s_mul_i32 s50, s50, 28672
s_add_u32 m0, s40, 0
s_add_u32 s41, s50, 128
s_waitcnt lgkmcnt(0)
buffer_load_dwordx4 v14, s[44:47], s41 offen lds
v_mfma_f32_32x32x16_bf16 v[176:191], v[252:255], a[76:79], v[176:191]
buffer_load_dwordx4 v15, s[44:47], s41 offen offset:1024 lds
v_mfma_f32_32x32x16_bf16 v[128:143], v[208:211], a[80:83], v[128:143]
ds_read_b128 a[96:99], v28 offset:57344
ds_read_b128 a[100:103], v28 offset:58368
ds_read_b128 a[104:107], v28 offset:59392
buffer_load_dwordx4 v16, s[44:47], s41 offen offset:2048 lds
v_mfma_f32_32x32x16_bf16 v[144:159], v[208:211], a[84:87], v[144:159]
ds_read_b128 a[108:111], v28 offset:60416
buffer_load_dwordx4 v17, s[44:47], s41 offen offset:3072 lds
v_mfma_f32_32x32x16_bf16 v[160:175], v[212:215], a[80:83], v[160:175]
v_mfma_f32_32x32x16_bf16 v[176:191], v[212:215], a[84:87], v[176:191]
v_mfma_f32_32x32x16_bf16 v[128:143], v[216:219], a[88:91], v[128:143]
v_mfma_f32_32x32x16_bf16 v[144:159], v[216:219], a[92:95], v[144:159]
v_mfma_f32_32x32x16_bf16 v[160:175], v[220:223], a[88:91], v[160:175]
v_mfma_f32_32x32x16_bf16 v[176:191], v[220:223], a[92:95], v[176:191]
s_waitcnt lgkmcnt(3)
v_mfma_f32_32x32x16_bf16 v[128:143], v[224:227], a[96:99], v[128:143]
ds_read_b128 a[112:115], v28 offset:61440
ds_read_b128 a[116:119], v28 offset:62464
ds_read_b128 a[120:123], v28 offset:63488
s_waitcnt lgkmcnt(5)
v_mfma_f32_32x32x16_bf16 v[144:159], v[224:227], a[100:103], v[144:159]
ds_read_b128 a[124:127], v28 offset:64512
s_waitcnt vmcnt(20)
ds_read_b64_tr_b16 a[128:129], v26 offset:4096
v_mfma_f32_32x32x16_bf16 v[160:175], v[228:231], a[96:99], v[160:175]
ds_read_b64_tr_b16 a[130:131], v26 offset:5120
ds_read_b64_tr_b16 a[132:133], v27 offset:4096
ds_read_b64_tr_b16 a[134:135], v27 offset:5120
v_mfma_f32_32x32x16_bf16 v[176:191], v[228:231], a[100:103], v[176:191]
ds_read_b64_tr_b16 a[136:137], v26 offset:6144
ds_read_b64_tr_b16 a[138:139], v26 offset:7168
ds_read_b64_tr_b16 a[140:141], v27 offset:6144
s_waitcnt lgkmcnt(12)
v_mfma_f32_32x32x16_bf16 v[128:143], v[232:235], a[104:107], v[128:143]
ds_read_b64_tr_b16 a[142:143], v27 offset:7168
s_waitcnt lgkmcnt(12)
v_mfma_f32_32x32x16_bf16 v[144:159], v[232:235], a[108:111], v[144:159]
v_mfma_f32_32x32x16_bf16 v[160:175], v[236:239], a[104:107], v[160:175]
s_add_u32 s50, s7, 7
s_and_b32 s50, s50, 7
s_mul_i32 s50, s50, 28672
s_add_u32 m0, s40, 4096
s_add_u32 s41, s50, 128
s_waitcnt lgkmcnt(0)
buffer_load_dwordx4 v14, s[44:47], s41 offen lds
v_mfma_f32_32x32x16_bf16 v[176:191], v[236:239], a[108:111], v[176:191]
buffer_load_dwordx4 v15, s[44:47], s41 offen offset:1024 lds
v_mfma_f32_32x32x16_bf16 v[128:143], v[192:195], a[112:115], v[128:143]
s_waitcnt vmcnt(18)
ds_read_b64_tr_b16 a[160:161], v26 offset:8192
ds_read_b64_tr_b16 a[162:163], v26 offset:9216
buffer_load_dwordx4 v16, s[44:47], s41 offen offset:2048 lds
v_mfma_f32_32x32x16_bf16 v[128:143], v[200:203], a[120:123], v[128:143]
ds_read_b64_tr_b16 a[164:165], v27 offset:8192
ds_read_b64_tr_b16 a[166:167], v27 offset:9216
ds_read_b64_tr_b16 a[168:169], v26 offset:10240
buffer_load_dwordx4 v17, s[44:47], s41 offen offset:3072 lds
v_mfma_f32_32x32x16_bf16 v[144:159], v[192:195], a[116:119], v[144:159]
ds_read_b64_tr_b16 a[170:171], v26 offset:11264
ds_read_b64_tr_b16 a[172:173], v27 offset:10240
ds_read_b64_tr_b16 a[174:175], v27 offset:11264
v_mfma_f32_32x32x16_bf16 v[144:159], v[200:203], a[124:127], v[144:159]
v_mfma_f32_32x32x16_bf16 v[160:175], v[196:199], a[112:115], v[160:175]
v_mfma_f32_32x32x16_bf16 v[160:175], v[204:207], a[120:123], v[160:175]
v_mfma_f32_32x32x16_bf16 v[176:191], v[196:199], a[116:119], v[176:191]
v_mfma_f32_32x32x16_bf16 v[176:191], v[204:207], a[124:127], v[176:191]
s_cmp_eq_u32 s9, 3
s_cbranch_scc1 L_w3A
v_mfma_f32_32x32x16_bf16 v[192:207], a[144:147], a[0:3], 0
s_waitcnt vmcnt(16)
ds_read_b64_tr_b16 a[176:177], v26 offset:12288
ds_read_b64_tr_b16 a[178:179], v26 offset:13312
v_mfma_f32_32x32x16_bf16 v[208:223], a[144:147], a[4:7], 0
ds_read_b64_tr_b16 a[180:181], v27 offset:12288
ds_read_b64_tr_b16 a[182:183], v27 offset:13312
ds_read_b64_tr_b16 a[184:185], v26 offset:14336
v_mfma_f32_32x32x16_bf16 v[224:239], a[148:151], a[0:3], 0
ds_read_b64_tr_b16 a[186:187], v26 offset:15360
ds_read_b64_tr_b16 a[188:189], v27 offset:14336
ds_read_b64_tr_b16 a[190:191], v27 offset:15360
v_cvt_pk_bf16_f32 v80, v128, v129
v_cvt_pk_bf16_f32 v81, v130, v131
v_cvt_pk_bf16_f32 v82, v132, v133
v_cvt_pk_bf16_f32 v83, v134, v135
s_mov_b32 s51, 0
buffer_store_dwordx4 v[80:83], v33, s[32:35], s51 offen sc1
v_mfma_f32_32x32x16_bf16 v[240:255], a[148:151], a[4:7], 0
v_cvt_pk_bf16_f32 v84, v136, v137
v_cvt_pk_bf16_f32 v85, v138, v139
v_cvt_pk_bf16_f32 v86, v140, v141
v_cvt_pk_bf16_f32 v87, v142, v143
s_mov_b32 s51, 1024
buffer_store_dwordx4 v[84:87], v33, s[32:35], s51 offen sc1
v_mfma_f32_32x32x16_bf16 v[192:207], a[152:155], a[8:11], v[192:207]
v_cvt_pk_bf16_f32 v88, v144, v145
v_cvt_pk_bf16_f32 v89, v146, v147
v_cvt_pk_bf16_f32 v90, v148, v149
v_cvt_pk_bf16_f32 v91, v150, v151
s_mov_b32 s51, 2048
buffer_store_dwordx4 v[88:91], v33, s[32:35], s51 offen sc1
v_mfma_f32_32x32x16_bf16 v[208:223], a[152:155], a[12:15], v[208:223]
v_cvt_pk_bf16_f32 v92, v152, v153
v_cvt_pk_bf16_f32 v93, v154, v155
v_cvt_pk_bf16_f32 v94, v156, v157
v_cvt_pk_bf16_f32 v95, v158, v159
s_mov_b32 s51, 3072
buffer_store_dwordx4 v[92:95], v33, s[32:35], s51 offen sc1
v_mfma_f32_32x32x16_bf16 v[224:239], a[156:159], a[8:11], v[224:239]
v_cvt_pk_bf16_f32 v80, v160, v161
v_cvt_pk_bf16_f32 v81, v162, v163
v_cvt_pk_bf16_f32 v82, v164, v165
v_cvt_pk_bf16_f32 v83, v166, v167
s_mov_b32 s51, 4096
buffer_store_dwordx4 v[80:83], v33, s[32:35], s51 offen sc1
v_mfma_f32_32x32x16_bf16 v[240:255], a[156:159], a[12:15], v[240:255]
v_cvt_pk_bf16_f32 v84, v168, v169
v_cvt_pk_bf16_f32 v85, v170, v171
v_cvt_pk_bf16_f32 v86, v172, v173
v_cvt_pk_bf16_f32 v87, v174, v175
s_mov_b32 s51, 5120
buffer_store_dwordx4 v[84:87], v33, s[32:35], s51 offen sc1
v_mfma_f32_32x32x16_bf16 v[192:207], a[128:131], a[16:19], v[192:207]
s_waitcnt vmcnt(18)
ds_read_b64_tr_b16 a[144:145], v26 offset:16384
ds_read_b64_tr_b16 a[146:147], v26 offset:17408
v_cvt_pk_bf16_f32 v88, v176, v177
v_cvt_pk_bf16_f32 v89, v178, v179
v_cvt_pk_bf16_f32 v90, v180, v181
v_cvt_pk_bf16_f32 v91, v182, v183
s_mov_b32 s51, 6144
buffer_store_dwordx4 v[88:91], v33, s[32:35], s51 offen sc1
v_mfma_f32_32x32x16_bf16 v[208:223], a[128:131], a[20:23], v[208:223]
ds_read_b64_tr_b16 a[148:149], v27 offset:16384
ds_read_b64_tr_b16 a[150:151], v27 offset:17408
ds_read_b64_tr_b16 a[152:153], v26 offset:18432
v_cvt_pk_bf16_f32 v92, v184, v185
v_cvt_pk_bf16_f32 v93, v186, v187
v_cvt_pk_bf16_f32 v94, v188, v189
v_cvt_pk_bf16_f32 v95, v190, v191
s_mov_b32 s51, 7168
buffer_store_dwordx4 v[92:95], v33, s[32:35], s51 offen sc1
v_mfma_f32_32x32x16_bf16 v[224:239], a[132:135], a[16:19], v[224:239]
ds_read_b64_tr_b16 a[154:155], v26 offset:19456
ds_read_b64_tr_b16 a[156:157], v27 offset:18432
ds_read_b64_tr_b16 a[158:159], v27 offset:19456
v_mfma_f32_32x32x16_bf16 v[240:255], a[132:135], a[20:23], v[240:255]
v_mfma_f32_32x32x16_bf16 v[192:207], a[136:139], a[24:27], v[192:207]
v_mfma_f32_32x32x16_bf16 v[208:223], a[136:139], a[28:31], v[208:223]
v_mfma_f32_32x32x16_bf16 v[224:239], a[140:143], a[24:27], v[224:239]
v_mfma_f32_32x32x16_bf16 v[240:255], a[140:143], a[28:31], v[240:255]
s_waitcnt lgkmcnt(14)
v_mfma_f32_32x32x16_bf16 v[192:207], a[160:163], a[32:35], v[192:207]
s_waitcnt vmcnt(16)
ds_read_b64_tr_b16 a[128:129], v26 offset:20480
ds_read_b64_tr_b16 a[130:131], v26 offset:21504
v_mfma_f32_32x32x16_bf16 v[208:223], a[160:163], a[36:39], v[208:223]
ds_read_b64_tr_b16 a[132:133], v27 offset:20480
ds_read_b64_tr_b16 a[134:135], v27 offset:21504
ds_read_b64_tr_b16 a[136:137], v26 offset:22528
v_mfma_f32_32x32x16_bf16 v[224:239], a[164:167], a[32:35], v[224:239]
ds_read_b64_tr_b16 a[138:139], v26 offset:23552
ds_read_b64_tr_b16 a[140:141], v27 offset:22528
ds_read_b64_tr_b16 a[142:143], v27 offset:23552
v_mfma_f32_32x32x16_bf16 v[240:255], a[164:167], a[36:39], v[240:255]
v_mfma_f32_32x32x16_bf16 v[192:207], a[168:171], a[40:43], v[192:207]
v_mfma_f32_32x32x16_bf16 v[208:223], a[168:171], a[44:47], v[208:223]
v_mfma_f32_32x32x16_bf16 v[224:239], a[172:175], a[40:43], v[224:239]
v_mfma_f32_32x32x16_bf16 v[240:255], a[172:175], a[44:47], v[240:255]
v_mfma_f32_32x32x16_bf16 v[192:207], a[176:179], a[48:51], v[192:207]
s_waitcnt vmcnt(12)
ds_read_b64_tr_b16 a[160:161], v26 offset:0
ds_read_b64_tr_b16 a[162:163], v26 offset:1024
v_mfma_f32_32x32x16_bf16 v[208:223], a[176:179], a[52:55], v[208:223]
ds_read_b64_tr_b16 a[164:165], v27 offset:0
ds_read_b64_tr_b16 a[166:167], v27 offset:1024
ds_read_b64_tr_b16 a[168:169], v26 offset:2048
s_waitcnt lgkmcnt(14)
v_mfma_f32_32x32x16_bf16 v[224:239], a[180:183], a[48:51], v[224:239]
ds_read_b64_tr_b16 a[170:171], v26 offset:3072
ds_read_b64_tr_b16 a[172:173], v27 offset:2048
ds_read_b64_tr_b16 a[174:175], v27 offset:3072
v_mfma_f32_32x32x16_bf16 v[240:255], a[180:183], a[52:55], v[240:255]
v_mfma_f32_32x32x16_bf16 v[192:207], a[184:187], a[56:59], v[192:207]
v_mfma_f32_32x32x16_bf16 v[208:223], a[184:187], a[60:63], v[208:223]
v_mfma_f32_32x32x16_bf16 v[224:239], a[188:191], a[56:59], v[224:239]
v_mfma_f32_32x32x16_bf16 v[240:255], a[188:191], a[60:63], v[240:255]
v_mfma_f32_32x32x16_bf16 v[192:207], a[144:147], a[64:67], v[192:207]
s_waitcnt vmcnt(8)
ds_read_b64_tr_b16 a[176:177], v26 offset:4096
ds_read_b64_tr_b16 a[178:179], v26 offset:5120
v_mfma_f32_32x32x16_bf16 v[208:223], a[144:147], a[68:71], v[208:223]
ds_read_b64_tr_b16 a[180:181], v27 offset:4096
ds_read_b64_tr_b16 a[182:183], v27 offset:5120
ds_read_b64_tr_b16 a[184:185], v26 offset:6144
v_mfma_f32_32x32x16_bf16 v[224:239], a[148:151], a[64:67], v[224:239]
ds_read_b64_tr_b16 a[186:187], v26 offset:7168
ds_read_b64_tr_b16 a[188:189], v27 offset:6144
ds_read_b64_tr_b16 a[190:191], v27 offset:7168
v_mfma_f32_32x32x16_bf16 v[240:255], a[148:151], a[68:71], v[240:255]
v_mfma_f32_32x32x16_bf16 v[192:207], a[152:155], a[72:75], v[192:207]
v_mfma_f32_32x32x16_bf16 v[208:223], a[152:155], a[76:79], v[208:223]
s_waitcnt lgkmcnt(14)
v_mfma_f32_32x32x16_bf16 v[224:239], a[156:159], a[72:75], v[224:239]
v_mfma_f32_32x32x16_bf16 v[240:255], a[156:159], a[76:79], v[240:255]
v_mfma_f32_32x32x16_bf16 v[192:207], a[128:131], a[80:83], v[192:207]
v_mfma_f32_32x32x16_bf16 v[208:223], a[128:131], a[84:87], v[208:223]
v_mfma_f32_32x32x16_bf16 v[224:239], a[132:135], a[80:83], v[224:239]
v_mfma_f32_32x32x16_bf16 v[240:255], a[132:135], a[84:87], v[240:255]
v_mfma_f32_32x32x16_bf16 v[192:207], a[136:139], a[88:91], v[192:207]
v_mfma_f32_32x32x16_bf16 v[208:223], a[136:139], a[92:95], v[208:223]
v_mfma_f32_32x32x16_bf16 v[224:239], a[140:143], a[88:91], v[224:239]
v_mfma_f32_32x32x16_bf16 v[240:255], a[140:143], a[92:95], v[240:255]
s_waitcnt vmcnt(0)
s_mul_i32 s10, s9, 1280
s_lshl_b32 s11, s6, 3
s_add_u32 s10, s10, s11
s_add_u32 s10, s10, 0
v_mov_b32 v42, s10
v_mov_b32 v40, s100
v_mov_b32 v41, s101
s_mov_b64 exec, 1
global_store_dwordx2 v42, v[40:41], s[76:77] sc1
s_mov_b64 exec, -1
v_mfma_f32_32x32x16_bf16 v[192:207], a[160:163], a[96:99], v[192:207]
v_mfma_f32_32x32x16_bf16 v[208:223], a[160:163], a[100:103], v[208:223]
s_waitcnt lgkmcnt(12)
v_mfma_f32_32x32x16_bf16 v[224:239], a[164:167], a[96:99], v[224:239]
v_mfma_f32_32x32x16_bf16 v[240:255], a[164:167], a[100:103], v[240:255]
s_waitcnt lgkmcnt(10)
v_mfma_f32_32x32x16_bf16 v[192:207], a[168:171], a[104:107], v[192:207]
v_mfma_f32_32x32x16_bf16 v[208:223], a[168:171], a[108:111], v[208:223]
s_waitcnt lgkmcnt(8)
v_mfma_f32_32x32x16_bf16 v[224:239], a[172:175], a[104:107], v[224:239]
v_mfma_f32_32x32x16_bf16 v[240:255], a[172:175], a[108:111], v[240:255]
s_waitcnt lgkmcnt(6)
v_mfma_f32_32x32x16_bf16 v[192:207], a[176:179], a[112:115], v[192:207]
s_waitcnt lgkmcnt(2)
v_mfma_f32_32x32x16_bf16 v[192:207], a[184:187], a[120:123], v[192:207]
v_mfma_f32_32x32x16_bf16 v[208:223], a[176:179], a[116:119], v[208:223]
v_mfma_f32_32x32x16_bf16 v[208:223], a[184:187], a[124:127], v[208:223]
v_mfma_f32_32x32x16_bf16 v[224:239], a[180:183], a[112:115], v[224:239]
s_waitcnt lgkmcnt(0)
v_mfma_f32_32x32x16_bf16 v[224:239], a[188:191], a[120:123], v[224:239]
v_mfma_f32_32x32x16_bf16 v[240:255], a[180:183], a[116:119], v[240:255]
v_mfma_f32_32x32x16_bf16 v[240:255], a[188:191], a[124:127], v[240:255]
s_nop 4
v_cvt_pk_bf16_f32 v80, v192, v193
v_cvt_pk_bf16_f32 v81, v194, v195
v_cvt_pk_bf16_f32 v82, v196, v197
v_cvt_pk_bf16_f32 v83, v198, v199
s_mov_b32 s51, 8192
buffer_store_dwordx4 v[80:83], v33, s[32:35], s51 offen sc1
v_cvt_pk_bf16_f32 v84, v200, v201
v_cvt_pk_bf16_f32 v85, v202, v203
v_cvt_pk_bf16_f32 v86, v204, v205
v_cvt_pk_bf16_f32 v87, v206, v207
s_mov_b32 s51, 9216
buffer_store_dwordx4 v[84:87], v33, s[32:35], s51 offen sc1
v_cvt_pk_bf16_f32 v88, v208, v209
v_cvt_pk_bf16_f32 v89, v210, v211
v_cvt_pk_bf16_f32 v90, v212, v213
v_cvt_pk_bf16_f32 v91, v214, v215
s_mov_b32 s51, 10240
buffer_store_dwordx4 v[88:91], v33, s[32:35], s51 offen sc1
v_cvt_pk_bf16_f32 v92, v216, v217
v_cvt_pk_bf16_f32 v93, v218, v219
v_cvt_pk_bf16_f32 v94, v220, v221
v_cvt_pk_bf16_f32 v95, v222, v223
s_mov_b32 s51, 11264
buffer_store_dwordx4 v[92:95], v33, s[32:35], s51 offen sc1
v_cvt_pk_bf16_f32 v80, v224, v225
v_cvt_pk_bf16_f32 v81, v226, v227
v_cvt_pk_bf16_f32 v82, v228, v229
v_cvt_pk_bf16_f32 v83, v230, v231
s_mov_b32 s51, 12288
buffer_store_dwordx4 v[80:83], v33, s[32:35], s51 offen sc1
v_cvt_pk_bf16_f32 v84, v232, v233
v_cvt_pk_bf16_f32 v85, v234, v235
v_cvt_pk_bf16_f32 v86, v236, v237
v_cvt_pk_bf16_f32 v87, v238, v239
s_mov_b32 s51, 13312
buffer_store_dwordx4 v[84:87], v33, s[32:35], s51 offen sc1
v_cvt_pk_bf16_f32 v88, v240, v241
v_cvt_pk_bf16_f32 v89, v242, v243
v_cvt_pk_bf16_f32 v90, v244, v245
v_cvt_pk_bf16_f32 v91, v246, v247
s_mov_b32 s51, 14336
buffer_store_dwordx4 v[88:91], v33, s[32:35], s51 offen sc1
v_cvt_pk_bf16_f32 v92, v248, v249
v_cvt_pk_bf16_f32 v93, v250, v251
v_cvt_pk_bf16_f32 v94, v252, v253
v_cvt_pk_bf16_f32 v95, v254, v255
s_mov_b32 s51, 15360
buffer_store_dwordx4 v[92:95], v33, s[32:35], s51 offen sc1
s_branch L_tail
L_w3A:
s_nop 7
s_nop 7
s_waitcnt lgkmcnt(0)
v_cvt_pk_bf16_f32 v80, v128, v129
v_cvt_pk_bf16_f32 v81, v130, v131
v_cvt_pk_bf16_f32 v82, v132, v133
v_cvt_pk_bf16_f32 v83, v134, v135
s_mov_b32 s51, 0
buffer_store_dwordx4 v[80:83], v33, s[32:35], s51 offen sc1
v_cvt_pk_bf16_f32 v84, v136, v137
v_cvt_pk_bf16_f32 v85, v138, v139
v_cvt_pk_bf16_f32 v86, v140, v141
v_cvt_pk_bf16_f32 v87, v142, v143
s_mov_b32 s51, 1024
buffer_store_dwordx4 v[84:87], v33, s[32:35], s51 offen sc1
v_cvt_pk_bf16_f32 v88, v144, v145
v_cvt_pk_bf16_f32 v89, v146, v147
v_cvt_pk_bf16_f32 v90, v148, v149
v_cvt_pk_bf16_f32 v91, v150, v151
s_mov_b32 s51, 2048
buffer_store_dwordx4 v[88:91], v33, s[32:35], s51 offen sc1
v_cvt_pk_bf16_f32 v92, v152, v153
v_cvt_pk_bf16_f32 v93, v154, v155
v_cvt_pk_bf16_f32 v94, v156, v157
v_cvt_pk_bf16_f32 v95, v158, v159
s_mov_b32 s51, 3072
buffer_store_dwordx4 v[92:95], v33, s[32:35], s51 offen sc1
v_cvt_pk_bf16_f32 v80, v160, v161
v_cvt_pk_bf16_f32 v81, v162, v163
v_cvt_pk_bf16_f32 v82, v164, v165
v_cvt_pk_bf16_f32 v83, v166, v167
s_mov_b32 s51, 4096
buffer_store_dwordx4 v[80:83], v33, s[32:35], s51 offen sc1
v_cvt_pk_bf16_f32 v84, v168, v169
v_cvt_pk_bf16_f32 v85, v170, v171
v_cvt_pk_bf16_f32 v86, v172, v173
v_cvt_pk_bf16_f32 v87, v174, v175
s_mov_b32 s51, 5120
buffer_store_dwordx4 v[84:87], v33, s[32:35], s51 offen sc1
v_cvt_pk_bf16_f32 v88, v176, v177
v_cvt_pk_bf16_f32 v89, v178, v179
v_cvt_pk_bf16_f32 v90, v180, v181
v_cvt_pk_bf16_f32 v91, v182, v183
s_mov_b32 s51, 6144
buffer_store_dwordx4 v[88:91], v33, s[32:35], s51 offen sc1
v_cvt_pk_bf16_f32 v92, v184, v185
v_cvt_pk_bf16_f32 v93, v186, v187
v_cvt_pk_bf16_f32 v94, v188, v189
v_cvt_pk_bf16_f32 v95, v190, v191
s_mov_b32 s51, 7168
buffer_store_dwordx4 v[92:95], v33, s[32:35], s51 offen sc1
s_branch L_tail3
L_tail:
s_mul_i32 s46, s6, 3
s_add_u32 s46, s46, s9
s_lshr_b32 s47, s46, 4
s_and_b32 s46, s46, 15
s_lshl_b32 s46, s46, 5
s_lshl_b32 s45, s47, 10
s_add_u32 s46, s46, s45
s_add_u32 s46, s46, 512
v_add_u32 v1, s46, v0
v_lshlrev_b32 v2, 4, v1
v_bfe_u32 v4, v1, 7, 1
v_and_b32 v5, 31, v1
v_lshl_add_u32 v4, v4, 5, v5
v_mul_u32_u24 v4, 1792, v4
v_lshrrev_b32 v5, 8, v1
v_lshl_add_u32 v4, v5, 6, v4
v_bfe_u32 v5, v1, 6, 1
v_lshl_add_u32 v4, v5, 5, v4
v_bfe_u32 v5, v1, 5, 1
v_lshl_add_u32 v4, v5, 4, v4
s_mul_i32 s10, s7, 114688
s_mul_i32 s11, s5, 896
s_add_u32 s10, s10, s11
v_add_u32 v4, s10, v4
s_mul_i32 s50, s47, 1280
s_add_u32 s50, s50, 5120
s_waitcnt vmcnt(0)
s_mul_i32 s10, s9, 1280
s_lshl_b32 s11, s6, 3
s_add_u32 s10, s10, s11
s_add_u32 s10, s10, 5120
v_mov_b32 v42, s10
v_mov_b32 v40, s100
v_mov_b32 v41, s101
s_mov_b64 exec, 1
global_store_dwordx2 v42, v[40:41], s[76:77] sc1
s_mov_b64 exec, -1
v_lshlrev_b32 v6, 3, v0
v_add_u32 v6, s50, v6
s_mov_b64 exec, 0xffff
L_poll1:
global_load_dwordx2 v[8:9], v6, s[76:77] sc1
s_waitcnt vmcnt(0)
v_cmp_eq_u64 vcc, s[100:101], v[8:9]
s_nop 1
s_cmp_eq_u64 vcc, exec
s_cbranch_scc1 L_poll1_done
s_branch L_poll1
L_poll1_done:
s_mov_b64 exec, -1
s_mov_b32 exec_lo, -1
s_mov_b32 exec_hi, 0
s_mov_b32 s41, 0
s_nop 7
buffer_load_dwordx4 v[128:131], v2, s[80:83], s41 offen sc1
s_mov_b32 s41, 57344
buffer_load_dwordx4 v[132:135], v2, s[80:83], s41 offen sc1
s_mov_b32 s41, 114688
buffer_load_dwordx4 v[136:139], v2, s[80:83], s41 offen sc1
s_mov_b32 s41, 172032
buffer_load_dwordx4 v[140:143], v2, s[80:83], s41 offen sc1
s_mov_b32 s41, 229376
buffer_load_dwordx4 v[144:147], v2, s[80:83], s41 offen sc1
s_mov_b32 s41, 286720
buffer_load_dwordx4 v[148:151], v2, s[80:83], s41 offen sc1
s_mov_b32 s41, 344064
buffer_load_dwordx4 v[152:155], v2, s[80:83], s41 offen sc1
s_mov_b32 s41, 401408
buffer_load_dwordx4 v[156:159], v2, s[80:83], s41 offen sc1
s_mov_b32 s41, 458752
buffer_load_dwordx4 v[160:163], v2, s[80:83], s41 offen sc1
s_mov_b32 s41, 516096
buffer_load_dwordx4 v[164:167], v2, s[80:83], s41 offen sc1
s_mov_b32 s41, 573440
buffer_load_dwordx4 v[168:171], v2, s[80:83], s41 offen sc1
s_mov_b32 s41, 630784
buffer_load_dwordx4 v[172:175], v2, s[80:83], s41 offen sc1
s_mov_b32 s41, 688128
buffer_load_dwordx4 v[176:179], v2, s[80:83], s41 offen sc1
s_mov_b32 s41, 745472
buffer_load_dwordx4 v[180:183], v2, s[80:83], s41 offen sc1
s_mov_b32 s41, 802816
buffer_load_dwordx4 v[184:187], v2, s[80:83], s41 offen sc1
s_mov_b32 s41, 860160
buffer_load_dwordx4 v[188:191], v2, s[80:83], s41 offen sc1
s_waitcnt vmcnt(15)
v_lshlrev_b32 v72, 16, v128
v_and_b32 v73, 0xffff0000, v128
v_lshlrev_b32 v74, 16, v129
v_and_b32 v75, 0xffff0000, v129
v_lshlrev_b32 v76, 16, v130
v_and_b32 v77, 0xffff0000, v130
v_lshlrev_b32 v78, 16, v131
v_and_b32 v79, 0xffff0000, v131
s_waitcnt vmcnt(14)
v_lshlrev_b32 v70, 16, v132
v_and_b32 v71, 0xffff0000, v132
v_add_f32 v72, v72, v70
v_add_f32 v73, v73, v71
v_lshlrev_b32 v70, 16, v133
v_and_b32 v71, 0xffff0000, v133
v_add_f32 v74, v74, v70
v_add_f32 v75, v75, v71
v_lshlrev_b32 v70, 16, v134
v_and_b32 v71, 0xffff0000, v134
v_add_f32 v76, v76, v70
v_add_f32 v77, v77, v71
v_lshlrev_b32 v70, 16, v135
v_and_b32 v71, 0xffff0000, v135
v_add_f32 v78, v78, v70
v_add_f32 v79, v79, v71
s_waitcnt vmcnt(13)
v_lshlrev_b32 v70, 16, v136
v_and_b32 v71, 0xffff0000, v136
v_add_f32 v72, v72, v70
v_add_f32 v73, v73, v71
v_lshlrev_b32 v70, 16, v137
v_and_b32 v71, 0xffff0000, v137
v_add_f32 v74, v74, v70
v_add_f32 v75, v75, v71
v_lshlrev_b32 v70, 16, v138
v_and_b32 v71, 0xffff0000, v138
v_add_f32 v76, v76, v70
v_add_f32 v77, v77, v71
v_lshlrev_b32 v70, 16, v139
v_and_b32 v71, 0xffff0000, v139
v_add_f32 v78, v78, v70
v_add_f32 v79, v79, v71
s_waitcnt vmcnt(12)
v_lshlrev_b32 v70, 16, v140
v_and_b32 v71, 0xffff0000, v140
v_add_f32 v72, v72, v70
v_add_f32 v73, v73, v71
v_lshlrev_b32 v70, 16, v141
v_and_b32 v71, 0xffff0000, v141
v_add_f32 v74, v74, v70
v_add_f32 v75, v75, v71
v_lshlrev_b32 v70, 16, v142
v_and_b32 v71, 0xffff0000, v142
v_add_f32 v76, v76, v70
v_add_f32 v77, v77, v71
v_lshlrev_b32 v70, 16, v143
v_and_b32 v71, 0xffff0000, v143
v_add_f32 v78, v78, v70
v_add_f32 v79, v79, v71
s_waitcnt vmcnt(11)
v_lshlrev_b32 v70, 16, v144
v_and_b32 v71, 0xffff0000, v144
v_add_f32 v72, v72, v70
v_add_f32 v73, v73, v71
v_lshlrev_b32 v70, 16, v145
v_and_b32 v71, 0xffff0000, v145
v_add_f32 v74, v74, v70
v_add_f32 v75, v75, v71
v_lshlrev_b32 v70, 16, v146
v_and_b32 v71, 0xffff0000, v146
v_add_f32 v76, v76, v70
v_add_f32 v77, v77, v71
v_lshlrev_b32 v70, 16, v147
v_and_b32 v71, 0xffff0000, v147
v_add_f32 v78, v78, v70
v_add_f32 v79, v79, v71
s_waitcnt vmcnt(10)
v_lshlrev_b32 v70, 16, v148
v_and_b32 v71, 0xffff0000, v148
v_add_f32 v72, v72, v70
v_add_f32 v73, v73, v71
v_lshlrev_b32 v70, 16, v149
v_and_b32 v71, 0xffff0000, v149
v_add_f32 v74, v74, v70
v_add_f32 v75, v75, v71
v_lshlrev_b32 v70, 16, v150
v_and_b32 v71, 0xffff0000, v150
v_add_f32 v76, v76, v70
v_add_f32 v77, v77, v71
v_lshlrev_b32 v70, 16, v151
v_and_b32 v71, 0xffff0000, v151
v_add_f32 v78, v78, v70
v_add_f32 v79, v79, v71
s_waitcnt vmcnt(9)
v_lshlrev_b32 v70, 16, v152
v_and_b32 v71, 0xffff0000, v152
v_add_f32 v72, v72, v70
v_add_f32 v73, v73, v71
v_lshlrev_b32 v70, 16, v153
v_and_b32 v71, 0xffff0000, v153
v_add_f32 v74, v74, v70
v_add_f32 v75, v75, v71
v_lshlrev_b32 v70, 16, v154
v_and_b32 v71, 0xffff0000, v154
v_add_f32 v76, v76, v70
v_add_f32 v77, v77, v71
v_lshlrev_b32 v70, 16, v155
v_and_b32 v71, 0xffff0000, v155
v_add_f32 v78, v78, v70
v_add_f32 v79, v79, v71
s_waitcnt vmcnt(8)
v_lshlrev_b32 v70, 16, v156
v_and_b32 v71, 0xffff0000, v156
v_add_f32 v72, v72, v70
v_add_f32 v73, v73, v71
v_lshlrev_b32 v70, 16, v157
v_and_b32 v71, 0xffff0000, v157
v_add_f32 v74, v74, v70
v_add_f32 v75, v75, v71
v_lshlrev_b32 v70, 16, v158
v_and_b32 v71, 0xffff0000, v158
v_add_f32 v76, v76, v70
v_add_f32 v77, v77, v71
v_lshlrev_b32 v70, 16, v159
v_and_b32 v71, 0xffff0000, v159
v_add_f32 v78, v78, v70
v_add_f32 v79, v79, v71
s_waitcnt vmcnt(7)
v_lshlrev_b32 v70, 16, v160
v_and_b32 v71, 0xffff0000, v160
v_add_f32 v72, v72, v70
v_add_f32 v73, v73, v71
v_lshlrev_b32 v70, 16, v161
v_and_b32 v71, 0xffff0000, v161
v_add_f32 v74, v74, v70
v_add_f32 v75, v75, v71
v_lshlrev_b32 v70, 16, v162
v_and_b32 v71, 0xffff0000, v162
v_add_f32 v76, v76, v70
v_add_f32 v77, v77, v71
v_lshlrev_b32 v70, 16, v163
v_and_b32 v71, 0xffff0000, v163
v_add_f32 v78, v78, v70
v_add_f32 v79, v79, v71
s_waitcnt vmcnt(6)
v_lshlrev_b32 v70, 16, v164
v_and_b32 v71, 0xffff0000, v164
v_add_f32 v72, v72, v70
v_add_f32 v73, v73, v71
v_lshlrev_b32 v70, 16, v165
v_and_b32 v71, 0xffff0000, v165
v_add_f32 v74, v74, v70
v_add_f32 v75, v75, v71
v_lshlrev_b32 v70, 16, v166
v_and_b32 v71, 0xffff0000, v166
v_add_f32 v76, v76, v70
v_add_f32 v77, v77, v71
v_lshlrev_b32 v70, 16, v167
v_and_b32 v71, 0xffff0000, v167
v_add_f32 v78, v78, v70
v_add_f32 v79, v79, v71
s_waitcnt vmcnt(5)
v_lshlrev_b32 v70, 16, v168
v_and_b32 v71, 0xffff0000, v168
v_add_f32 v72, v72, v70
v_add_f32 v73, v73, v71
v_lshlrev_b32 v70, 16, v169
v_and_b32 v71, 0xffff0000, v169
v_add_f32 v74, v74, v70
v_add_f32 v75, v75, v71
v_lshlrev_b32 v70, 16, v170
v_and_b32 v71, 0xffff0000, v170
v_add_f32 v76, v76, v70
v_add_f32 v77, v77, v71
v_lshlrev_b32 v70, 16, v171
v_and_b32 v71, 0xffff0000, v171
v_add_f32 v78, v78, v70
v_add_f32 v79, v79, v71
s_waitcnt vmcnt(4)
v_lshlrev_b32 v70, 16, v172
v_and_b32 v71, 0xffff0000, v172
v_add_f32 v72, v72, v70
v_add_f32 v73, v73, v71
v_lshlrev_b32 v70, 16, v173
v_and_b32 v71, 0xffff0000, v173
v_add_f32 v74, v74, v70
v_add_f32 v75, v75, v71
v_lshlrev_b32 v70, 16, v174
v_and_b32 v71, 0xffff0000, v174
v_add_f32 v76, v76, v70
v_add_f32 v77, v77, v71
v_lshlrev_b32 v70, 16, v175
v_and_b32 v71, 0xffff0000, v175
v_add_f32 v78, v78, v70
v_add_f32 v79, v79, v71
s_waitcnt vmcnt(3)
v_lshlrev_b32 v70, 16, v176
v_and_b32 v71, 0xffff0000, v176
v_add_f32 v72, v72, v70
v_add_f32 v73, v73, v71
v_lshlrev_b32 v70, 16, v177
v_and_b32 v71, 0xffff0000, v177
v_add_f32 v74, v74, v70
v_add_f32 v75, v75, v71
v_lshlrev_b32 v70, 16, v178
v_and_b32 v71, 0xffff0000, v178
v_add_f32 v76, v76, v70
v_add_f32 v77, v77, v71
v_lshlrev_b32 v70, 16, v179
v_and_b32 v71, 0xffff0000, v179
v_add_f32 v78, v78, v70
v_add_f32 v79, v79, v71
s_waitcnt vmcnt(2)
v_lshlrev_b32 v70, 16, v180
v_and_b32 v71, 0xffff0000, v180
v_add_f32 v72, v72, v70
v_add_f32 v73, v73, v71
v_lshlrev_b32 v70, 16, v181
v_and_b32 v71, 0xffff0000, v181
v_add_f32 v74, v74, v70
v_add_f32 v75, v75, v71
v_lshlrev_b32 v70, 16, v182
v_and_b32 v71, 0xffff0000, v182
v_add_f32 v76, v76, v70
v_add_f32 v77, v77, v71
v_lshlrev_b32 v70, 16, v183
v_and_b32 v71, 0xffff0000, v183
v_add_f32 v78, v78, v70
v_add_f32 v79, v79, v71
s_waitcnt vmcnt(1)
v_lshlrev_b32 v70, 16, v184
v_and_b32 v71, 0xffff0000, v184
v_add_f32 v72, v72, v70
v_add_f32 v73, v73, v71
v_lshlrev_b32 v70, 16, v185
v_and_b32 v71, 0xffff0000, v185
v_add_f32 v74, v74, v70
v_add_f32 v75, v75, v71
v_lshlrev_b32 v70, 16, v186
v_and_b32 v71, 0xffff0000, v186
v_add_f32 v76, v76, v70
v_add_f32 v77, v77, v71
v_lshlrev_b32 v70, 16, v187
v_and_b32 v71, 0xffff0000, v187
v_add_f32 v78, v78, v70
v_add_f32 v79, v79, v71
s_waitcnt vmcnt(0)
v_lshlrev_b32 v70, 16, v188
v_and_b32 v71, 0xffff0000, v188
v_add_f32 v72, v72, v70
v_add_f32 v73, v73, v71
v_lshlrev_b32 v70, 16, v189
v_and_b32 v71, 0xffff0000, v189
v_add_f32 v74, v74, v70
v_add_f32 v75, v75, v71
v_lshlrev_b32 v70, 16, v190
v_and_b32 v71, 0xffff0000, v190
v_add_f32 v76, v76, v70
v_add_f32 v77, v77, v71
v_lshlrev_b32 v70, 16, v191
v_and_b32 v71, 0xffff0000, v191
v_add_f32 v78, v78, v70
v_add_f32 v79, v79, v71
v_cvt_pk_bf16_f32 v80, v72, v73
v_cvt_pk_bf16_f32 v81, v74, v75
v_cvt_pk_bf16_f32 v82, v76, v77
v_cvt_pk_bf16_f32 v83, v78, v79
buffer_store_dwordx4 v[80:83], v4, s[84:87], 0 offen
s_mov_b64 exec, -1
s_branch L_fin
L_tail3:
s_lshr_b32 s47, s6, 2
s_and_b32 s46, s6, 3
s_lshl_b32 s46, s46, 7
s_lshl_b32 s45, s47, 10
s_add_u32 s46, s46, s45
v_add_u32 v1, s46, v0
v_lshlrev_b32 v2, 4, v1
v_bfe_u32 v4, v1, 7, 1
v_and_b32 v5, 31, v1
v_lshl_add_u32 v4, v4, 5, v5
v_mul_u32_u24 v4, 1792, v4
v_lshrrev_b32 v5, 8, v1
v_lshl_add_u32 v4, v5, 6, v4
v_bfe_u32 v5, v1, 6, 1
v_lshl_add_u32 v4, v5, 5, v4
v_bfe_u32 v5, v1, 5, 1
v_lshl_add_u32 v4, v5, 4, v4
s_mul_i32 s10, s7, 114688
s_mul_i32 s11, s5, 896
s_add_u32 s10, s10, s11
v_add_u32 v4, s10, v4
s_mul_i32 s50, s47, 1280
s_waitcnt vmcnt(0)
s_mul_i32 s10, s9, 1280
s_lshl_b32 s11, s6, 3
s_add_u32 s10, s10, s11
s_add_u32 s10, s10, 0
v_mov_b32 v42, s10
v_mov_b32 v40, s100
v_mov_b32 v41, s101
s_mov_b64 exec, 1
global_store_dwordx2 v42, v[40:41], s[76:77] sc1
s_mov_b64 exec, -1
v_lshlrev_b32 v6, 3, v0
v_add_u32 v6, s50, v6
s_mov_b64 exec, 0xffff
L_poll0:
global_load_dwordx2 v[8:9], v6, s[76:77] sc1
s_waitcnt vmcnt(0)
v_cmp_eq_u64 vcc, s[100:101], v[8:9]
s_nop 1
s_cmp_eq_u64 vcc, exec
s_cbranch_scc1 L_poll0_done
s_sleep 16
s_branch L_poll0
L_poll0_done:
s_mov_b64 exec, -1
s_mov_b32 s41, 0
s_nop 9
buffer_load_dwordx4 v[128:131], v2, s[80:83], s41 offen offset:0 sc1
s_mov_b32 s41, 57344
buffer_load_dwordx4 v[132:135], v2, s[80:83], s41 offen offset:0 sc1
s_mov_b32 s41, 114688
buffer_load_dwordx4 v[136:139], v2, s[80:83], s41 offen offset:0 sc1
s_mov_b32 s41, 172032
buffer_load_dwordx4 v[140:143], v2, s[80:83], s41 offen offset:0 sc1
s_mov_b32 s41, 229376
buffer_load_dwordx4 v[144:147], v2, s[80:83], s41 offen offset:0 sc1
s_mov_b32 s41, 286720
buffer_load_dwordx4 v[148:151], v2, s[80:83], s41 offen offset:0 sc1
s_mov_b32 s41, 344064
buffer_load_dwordx4 v[152:155], v2, s[80:83], s41 offen offset:0 sc1
s_mov_b32 s41, 401408
buffer_load_dwordx4 v[156:159], v2, s[80:83], s41 offen offset:0 sc1
s_mov_b32 s41, 458752
buffer_load_dwordx4 v[160:163], v2, s[80:83], s41 offen offset:0 sc1
s_mov_b32 s41, 516096
buffer_load_dwordx4 v[164:167], v2, s[80:83], s41 offen offset:0 sc1
s_mov_b32 s41, 573440
buffer_load_dwordx4 v[168:171], v2, s[80:83], s41 offen offset:0 sc1
s_mov_b32 s41, 630784
buffer_load_dwordx4 v[172:175], v2, s[80:83], s41 offen offset:0 sc1
s_mov_b32 s41, 688128
buffer_load_dwordx4 v[176:179], v2, s[80:83], s41 offen offset:0 sc1
s_mov_b32 s41, 745472
buffer_load_dwordx4 v[180:183], v2, s[80:83], s41 offen offset:0 sc1
s_mov_b32 s41, 802816
buffer_load_dwordx4 v[184:187], v2, s[80:83], s41 offen offset:0 sc1
s_mov_b32 s41, 860160
buffer_load_dwordx4 v[188:191], v2, s[80:83], s41 offen offset:0 sc1
s_mov_b32 s41, 0
buffer_load_dwordx4 v[192:195], v2, s[80:83], s41 offen offset:1024 sc1
s_mov_b32 s41, 57344
buffer_load_dwordx4 v[196:199], v2, s[80:83], s41 offen offset:1024 sc1
s_mov_b32 s41, 114688
buffer_load_dwordx4 v[200:203], v2, s[80:83], s41 offen offset:1024 sc1
s_mov_b32 s41, 172032
buffer_load_dwordx4 v[204:207], v2, s[80:83], s41 offen offset:1024 sc1
s_mov_b32 s41, 229376
buffer_load_dwordx4 v[208:211], v2, s[80:83], s41 offen offset:1024 sc1
s_mov_b32 s41, 286720
buffer_load_dwordx4 v[212:215], v2, s[80:83], s41 offen offset:1024 sc1
s_mov_b32 s41, 344064
buffer_load_dwordx4 v[216:219], v2, s[80:83], s41 offen offset:1024 sc1
s_mov_b32 s41, 401408
buffer_load_dwordx4 v[220:223], v2, s[80:83], s41 offen offset:1024 sc1
s_mov_b32 s41, 458752
buffer_load_dwordx4 v[224:227], v2, s[80:83], s41 offen offset:1024 sc1
s_mov_b32 s41, 516096
buffer_load_dwordx4 v[228:231], v2, s[80:83], s41 offen offset:1024 sc1
s_mov_b32 s41, 573440
buffer_load_dwordx4 v[232:235], v2, s[80:83], s41 offen offset:1024 sc1
s_mov_b32 s41, 630784
buffer_load_dwordx4 v[236:239], v2, s[80:83], s41 offen offset:1024 sc1
s_mov_b32 s41, 688128
buffer_load_dwordx4 v[240:243], v2, s[80:83], s41 offen offset:1024 sc1
s_mov_b32 s41, 745472
buffer_load_dwordx4 v[244:247], v2, s[80:83], s41 offen offset:1024 sc1
s_mov_b32 s41, 802816
buffer_load_dwordx4 v[248:251], v2, s[80:83], s41 offen offset:1024 sc1
s_mov_b32 s41, 860160
buffer_load_dwordx4 v[252:255], v2, s[80:83], s41 offen offset:1024 sc1
s_waitcnt vmcnt(31)
v_lshlrev_b32 v72, 16, v128
v_and_b32 v73, 0xffff0000, v128
v_lshlrev_b32 v74, 16, v129
v_and_b32 v75, 0xffff0000, v129
v_lshlrev_b32 v76, 16, v130
v_and_b32 v77, 0xffff0000, v130
v_lshlrev_b32 v78, 16, v131
v_and_b32 v79, 0xffff0000, v131
s_waitcnt vmcnt(30)
v_lshlrev_b32 v70, 16, v132
v_and_b32 v71, 0xffff0000, v132
v_add_f32 v72, v72, v70
v_add_f32 v73, v73, v71
v_lshlrev_b32 v70, 16, v133
v_and_b32 v71, 0xffff0000, v133
v_add_f32 v74, v74, v70
v_add_f32 v75, v75, v71
v_lshlrev_b32 v70, 16, v134
v_and_b32 v71, 0xffff0000, v134
v_add_f32 v76, v76, v70
v_add_f32 v77, v77, v71
v_lshlrev_b32 v70, 16, v135
v_and_b32 v71, 0xffff0000, v135
v_add_f32 v78, v78, v70
v_add_f32 v79, v79, v71
s_waitcnt vmcnt(29)
v_lshlrev_b32 v70, 16, v136
v_and_b32 v71, 0xffff0000, v136
v_add_f32 v72, v72, v70
v_add_f32 v73, v73, v71
v_lshlrev_b32 v70, 16, v137
v_and_b32 v71, 0xffff0000, v137
v_add_f32 v74, v74, v70
v_add_f32 v75, v75, v71
v_lshlrev_b32 v70, 16, v138
v_and_b32 v71, 0xffff0000, v138
v_add_f32 v76, v76, v70
v_add_f32 v77, v77, v71
v_lshlrev_b32 v70, 16, v139
v_and_b32 v71, 0xffff0000, v139
v_add_f32 v78, v78, v70
v_add_f32 v79, v79, v71
s_waitcnt vmcnt(28)
v_lshlrev_b32 v70, 16, v140
v_and_b32 v71, 0xffff0000, v140
v_add_f32 v72, v72, v70
v_add_f32 v73, v73, v71
v_lshlrev_b32 v70, 16, v141
v_and_b32 v71, 0xffff0000, v141
v_add_f32 v74, v74, v70
v_add_f32 v75, v75, v71
v_lshlrev_b32 v70, 16, v142
v_and_b32 v71, 0xffff0000, v142
v_add_f32 v76, v76, v70
v_add_f32 v77, v77, v71
v_lshlrev_b32 v70, 16, v143
v_and_b32 v71, 0xffff0000, v143
v_add_f32 v78, v78, v70
v_add_f32 v79, v79, v71
s_waitcnt vmcnt(27)
v_lshlrev_b32 v70, 16, v144
v_and_b32 v71, 0xffff0000, v144
v_add_f32 v72, v72, v70
v_add_f32 v73, v73, v71
v_lshlrev_b32 v70, 16, v145
v_and_b32 v71, 0xffff0000, v145
v_add_f32 v74, v74, v70
v_add_f32 v75, v75, v71
v_lshlrev_b32 v70, 16, v146
v_and_b32 v71, 0xffff0000, v146
v_add_f32 v76, v76, v70
v_add_f32 v77, v77, v71
v_lshlrev_b32 v70, 16, v147
v_and_b32 v71, 0xffff0000, v147
v_add_f32 v78, v78, v70
v_add_f32 v79, v79, v71
s_waitcnt vmcnt(26)
v_lshlrev_b32 v70, 16, v148
v_and_b32 v71, 0xffff0000, v148
v_add_f32 v72, v72, v70
v_add_f32 v73, v73, v71
v_lshlrev_b32 v70, 16, v149
v_and_b32 v71, 0xffff0000, v149
v_add_f32 v74, v74, v70
v_add_f32 v75, v75, v71
v_lshlrev_b32 v70, 16, v150
v_and_b32 v71, 0xffff0000, v150
v_add_f32 v76, v76, v70
v_add_f32 v77, v77, v71
v_lshlrev_b32 v70, 16, v151
v_and_b32 v71, 0xffff0000, v151
v_add_f32 v78, v78, v70
v_add_f32 v79, v79, v71
s_waitcnt vmcnt(25)
v_lshlrev_b32 v70, 16, v152
v_and_b32 v71, 0xffff0000, v152
v_add_f32 v72, v72, v70
v_add_f32 v73, v73, v71
v_lshlrev_b32 v70, 16, v153
v_and_b32 v71, 0xffff0000, v153
v_add_f32 v74, v74, v70
v_add_f32 v75, v75, v71
v_lshlrev_b32 v70, 16, v154
v_and_b32 v71, 0xffff0000, v154
v_add_f32 v76, v76, v70
v_add_f32 v77, v77, v71
v_lshlrev_b32 v70, 16, v155
v_and_b32 v71, 0xffff0000, v155
v_add_f32 v78, v78, v70
v_add_f32 v79, v79, v71
s_waitcnt vmcnt(24)
v_lshlrev_b32 v70, 16, v156
v_and_b32 v71, 0xffff0000, v156
v_add_f32 v72, v72, v70
v_add_f32 v73, v73, v71
v_lshlrev_b32 v70, 16, v157
v_and_b32 v71, 0xffff0000, v157
v_add_f32 v74, v74, v70
v_add_f32 v75, v75, v71
v_lshlrev_b32 v70, 16, v158
v_and_b32 v71, 0xffff0000, v158
v_add_f32 v76, v76, v70
v_add_f32 v77, v77, v71
v_lshlrev_b32 v70, 16, v159
v_and_b32 v71, 0xffff0000, v159
v_add_f32 v78, v78, v70
v_add_f32 v79, v79, v71
s_waitcnt vmcnt(23)
v_lshlrev_b32 v70, 16, v160
v_and_b32 v71, 0xffff0000, v160
v_add_f32 v72, v72, v70
v_add_f32 v73, v73, v71
v_lshlrev_b32 v70, 16, v161
v_and_b32 v71, 0xffff0000, v161
v_add_f32 v74, v74, v70
v_add_f32 v75, v75, v71
v_lshlrev_b32 v70, 16, v162
v_and_b32 v71, 0xffff0000, v162
v_add_f32 v76, v76, v70
v_add_f32 v77, v77, v71
v_lshlrev_b32 v70, 16, v163
v_and_b32 v71, 0xffff0000, v163
v_add_f32 v78, v78, v70
v_add_f32 v79, v79, v71
s_waitcnt vmcnt(22)
v_lshlrev_b32 v70, 16, v164
v_and_b32 v71, 0xffff0000, v164
v_add_f32 v72, v72, v70
v_add_f32 v73, v73, v71
v_lshlrev_b32 v70, 16, v165
v_and_b32 v71, 0xffff0000, v165
v_add_f32 v74, v74, v70
v_add_f32 v75, v75, v71
v_lshlrev_b32 v70, 16, v166
v_and_b32 v71, 0xffff0000, v166
v_add_f32 v76, v76, v70
v_add_f32 v77, v77, v71
v_lshlrev_b32 v70, 16, v167
v_and_b32 v71, 0xffff0000, v167
v_add_f32 v78, v78, v70
v_add_f32 v79, v79, v71
s_waitcnt vmcnt(21)
v_lshlrev_b32 v70, 16, v168
v_and_b32 v71, 0xffff0000, v168
v_add_f32 v72, v72, v70
v_add_f32 v73, v73, v71
v_lshlrev_b32 v70, 16, v169
v_and_b32 v71, 0xffff0000, v169
v_add_f32 v74, v74, v70
v_add_f32 v75, v75, v71
v_lshlrev_b32 v70, 16, v170
v_and_b32 v71, 0xffff0000, v170
v_add_f32 v76, v76, v70
v_add_f32 v77, v77, v71
v_lshlrev_b32 v70, 16, v171
v_and_b32 v71, 0xffff0000, v171
v_add_f32 v78, v78, v70
v_add_f32 v79, v79, v71
s_waitcnt vmcnt(20)
v_lshlrev_b32 v70, 16, v172
v_and_b32 v71, 0xffff0000, v172
v_add_f32 v72, v72, v70
v_add_f32 v73, v73, v71
v_lshlrev_b32 v70, 16, v173
v_and_b32 v71, 0xffff0000, v173
v_add_f32 v74, v74, v70
v_add_f32 v75, v75, v71
v_lshlrev_b32 v70, 16, v174
v_and_b32 v71, 0xffff0000, v174
v_add_f32 v76, v76, v70
v_add_f32 v77, v77, v71
v_lshlrev_b32 v70, 16, v175
v_and_b32 v71, 0xffff0000, v175
v_add_f32 v78, v78, v70
v_add_f32 v79, v79, v71
s_waitcnt vmcnt(19)
v_lshlrev_b32 v70, 16, v176
v_and_b32 v71, 0xffff0000, v176
v_add_f32 v72, v72, v70
v_add_f32 v73, v73, v71
v_lshlrev_b32 v70, 16, v177
v_and_b32 v71, 0xffff0000, v177
v_add_f32 v74, v74, v70
v_add_f32 v75, v75, v71
v_lshlrev_b32 v70, 16, v178
v_and_b32 v71, 0xffff0000, v178
v_add_f32 v76, v76, v70
v_add_f32 v77, v77, v71
v_lshlrev_b32 v70, 16, v179
v_and_b32 v71, 0xffff0000, v179
v_add_f32 v78, v78, v70
v_add_f32 v79, v79, v71
s_waitcnt vmcnt(18)
v_lshlrev_b32 v70, 16, v180
v_and_b32 v71, 0xffff0000, v180
v_add_f32 v72, v72, v70
v_add_f32 v73, v73, v71
v_lshlrev_b32 v70, 16, v181
v_and_b32 v71, 0xffff0000, v181
v_add_f32 v74, v74, v70
v_add_f32 v75, v75, v71
v_lshlrev_b32 v70, 16, v182
v_and_b32 v71, 0xffff0000, v182
v_add_f32 v76, v76, v70
v_add_f32 v77, v77, v71
v_lshlrev_b32 v70, 16, v183
v_and_b32 v71, 0xffff0000, v183
v_add_f32 v78, v78, v70
v_add_f32 v79, v79, v71
s_waitcnt vmcnt(17)
v_lshlrev_b32 v70, 16, v184
v_and_b32 v71, 0xffff0000, v184
v_add_f32 v72, v72, v70
v_add_f32 v73, v73, v71
v_lshlrev_b32 v70, 16, v185
v_and_b32 v71, 0xffff0000, v185
v_add_f32 v74, v74, v70
v_add_f32 v75, v75, v71
v_lshlrev_b32 v70, 16, v186
v_and_b32 v71, 0xffff0000, v186
v_add_f32 v76, v76, v70
v_add_f32 v77, v77, v71
v_lshlrev_b32 v70, 16, v187
v_and_b32 v71, 0xffff0000, v187
v_add_f32 v78, v78, v70
v_add_f32 v79, v79, v71
s_waitcnt vmcnt(16)
v_lshlrev_b32 v70, 16, v188
v_and_b32 v71, 0xffff0000, v188
v_add_f32 v72, v72, v70
v_add_f32 v73, v73, v71
v_lshlrev_b32 v70, 16, v189
v_and_b32 v71, 0xffff0000, v189
v_add_f32 v74, v74, v70
v_add_f32 v75, v75, v71
v_lshlrev_b32 v70, 16, v190
v_and_b32 v71, 0xffff0000, v190
v_add_f32 v76, v76, v70
v_add_f32 v77, v77, v71
v_lshlrev_b32 v70, 16, v191
v_and_b32 v71, 0xffff0000, v191
v_add_f32 v78, v78, v70
v_add_f32 v79, v79, v71
v_cvt_pk_bf16_f32 v80, v72, v73
v_cvt_pk_bf16_f32 v81, v74, v75
v_cvt_pk_bf16_f32 v82, v76, v77
v_cvt_pk_bf16_f32 v83, v78, v79
buffer_store_dwordx4 v[80:83], v4, s[84:87], 0 offen
s_waitcnt vmcnt(16)
v_lshlrev_b32 v72, 16, v192
v_and_b32 v73, 0xffff0000, v192
v_lshlrev_b32 v74, 16, v193
v_and_b32 v75, 0xffff0000, v193
v_lshlrev_b32 v76, 16, v194
v_and_b32 v77, 0xffff0000, v194
v_lshlrev_b32 v78, 16, v195
v_and_b32 v79, 0xffff0000, v195
s_waitcnt vmcnt(15)
v_lshlrev_b32 v70, 16, v196
v_and_b32 v71, 0xffff0000, v196
v_add_f32 v72, v72, v70
v_add_f32 v73, v73, v71
v_lshlrev_b32 v70, 16, v197
v_and_b32 v71, 0xffff0000, v197
v_add_f32 v74, v74, v70
v_add_f32 v75, v75, v71
v_lshlrev_b32 v70, 16, v198
v_and_b32 v71, 0xffff0000, v198
v_add_f32 v76, v76, v70
v_add_f32 v77, v77, v71
v_lshlrev_b32 v70, 16, v199
v_and_b32 v71, 0xffff0000, v199
v_add_f32 v78, v78, v70
v_add_f32 v79, v79, v71
s_waitcnt vmcnt(14)
v_lshlrev_b32 v70, 16, v200
v_and_b32 v71, 0xffff0000, v200
v_add_f32 v72, v72, v70
v_add_f32 v73, v73, v71
v_lshlrev_b32 v70, 16, v201
v_and_b32 v71, 0xffff0000, v201
v_add_f32 v74, v74, v70
v_add_f32 v75, v75, v71
v_lshlrev_b32 v70, 16, v202
v_and_b32 v71, 0xffff0000, v202
v_add_f32 v76, v76, v70
v_add_f32 v77, v77, v71
v_lshlrev_b32 v70, 16, v203
v_and_b32 v71, 0xffff0000, v203
v_add_f32 v78, v78, v70
v_add_f32 v79, v79, v71
s_waitcnt vmcnt(13)
v_lshlrev_b32 v70, 16, v204
v_and_b32 v71, 0xffff0000, v204
v_add_f32 v72, v72, v70
v_add_f32 v73, v73, v71
v_lshlrev_b32 v70, 16, v205
v_and_b32 v71, 0xffff0000, v205
v_add_f32 v74, v74, v70
v_add_f32 v75, v75, v71
v_lshlrev_b32 v70, 16, v206
v_and_b32 v71, 0xffff0000, v206
v_add_f32 v76, v76, v70
v_add_f32 v77, v77, v71
v_lshlrev_b32 v70, 16, v207
v_and_b32 v71, 0xffff0000, v207
v_add_f32 v78, v78, v70
v_add_f32 v79, v79, v71
s_waitcnt vmcnt(12)
v_lshlrev_b32 v70, 16, v208
v_and_b32 v71, 0xffff0000, v208
v_add_f32 v72, v72, v70
v_add_f32 v73, v73, v71
v_lshlrev_b32 v70, 16, v209
v_and_b32 v71, 0xffff0000, v209
v_add_f32 v74, v74, v70
v_add_f32 v75, v75, v71
v_lshlrev_b32 v70, 16, v210
v_and_b32 v71, 0xffff0000, v210
v_add_f32 v76, v76, v70
v_add_f32 v77, v77, v71
v_lshlrev_b32 v70, 16, v211
v_and_b32 v71, 0xffff0000, v211
v_add_f32 v78, v78, v70
v_add_f32 v79, v79, v71
s_waitcnt vmcnt(11)
v_lshlrev_b32 v70, 16, v212
v_and_b32 v71, 0xffff0000, v212
v_add_f32 v72, v72, v70
v_add_f32 v73, v73, v71
v_lshlrev_b32 v70, 16, v213
v_and_b32 v71, 0xffff0000, v213
v_add_f32 v74, v74, v70
v_add_f32 v75, v75, v71
v_lshlrev_b32 v70, 16, v214
v_and_b32 v71, 0xffff0000, v214
v_add_f32 v76, v76, v70
v_add_f32 v77, v77, v71
v_lshlrev_b32 v70, 16, v215
v_and_b32 v71, 0xffff0000, v215
v_add_f32 v78, v78, v70
v_add_f32 v79, v79, v71
s_waitcnt vmcnt(10)
v_lshlrev_b32 v70, 16, v216
v_and_b32 v71, 0xffff0000, v216
v_add_f32 v72, v72, v70
v_add_f32 v73, v73, v71
v_lshlrev_b32 v70, 16, v217
v_and_b32 v71, 0xffff0000, v217
v_add_f32 v74, v74, v70
v_add_f32 v75, v75, v71
v_lshlrev_b32 v70, 16, v218
v_and_b32 v71, 0xffff0000, v218
v_add_f32 v76, v76, v70
v_add_f32 v77, v77, v71
v_lshlrev_b32 v70, 16, v219
v_and_b32 v71, 0xffff0000, v219
v_add_f32 v78, v78, v70
v_add_f32 v79, v79, v71
s_waitcnt vmcnt(9)
v_lshlrev_b32 v70, 16, v220
v_and_b32 v71, 0xffff0000, v220
v_add_f32 v72, v72, v70
v_add_f32 v73, v73, v71
v_lshlrev_b32 v70, 16, v221
v_and_b32 v71, 0xffff0000, v221
v_add_f32 v74, v74, v70
v_add_f32 v75, v75, v71
v_lshlrev_b32 v70, 16, v222
v_and_b32 v71, 0xffff0000, v222
v_add_f32 v76, v76, v70
v_add_f32 v77, v77, v71
v_lshlrev_b32 v70, 16, v223
v_and_b32 v71, 0xffff0000, v223
v_add_f32 v78, v78, v70
v_add_f32 v79, v79, v71
s_waitcnt vmcnt(8)
v_lshlrev_b32 v70, 16, v224
v_and_b32 v71, 0xffff0000, v224
v_add_f32 v72, v72, v70
v_add_f32 v73, v73, v71
v_lshlrev_b32 v70, 16, v225
v_and_b32 v71, 0xffff0000, v225
v_add_f32 v74, v74, v70
v_add_f32 v75, v75, v71
v_lshlrev_b32 v70, 16, v226
v_and_b32 v71, 0xffff0000, v226
v_add_f32 v76, v76, v70
v_add_f32 v77, v77, v71
v_lshlrev_b32 v70, 16, v227
v_and_b32 v71, 0xffff0000, v227
v_add_f32 v78, v78, v70
v_add_f32 v79, v79, v71
s_waitcnt vmcnt(7)
v_lshlrev_b32 v70, 16, v228
v_and_b32 v71, 0xffff0000, v228
v_add_f32 v72, v72, v70
v_add_f32 v73, v73, v71
v_lshlrev_b32 v70, 16, v229
v_and_b32 v71, 0xffff0000, v229
v_add_f32 v74, v74, v70
v_add_f32 v75, v75, v71
v_lshlrev_b32 v70, 16, v230
v_and_b32 v71, 0xffff0000, v230
v_add_f32 v76, v76, v70
v_add_f32 v77, v77, v71
v_lshlrev_b32 v70, 16, v231
v_and_b32 v71, 0xffff0000, v231
v_add_f32 v78, v78, v70
v_add_f32 v79, v79, v71
s_waitcnt vmcnt(6)
v_lshlrev_b32 v70, 16, v232
v_and_b32 v71, 0xffff0000, v232
v_add_f32 v72, v72, v70
v_add_f32 v73, v73, v71
v_lshlrev_b32 v70, 16, v233
v_and_b32 v71, 0xffff0000, v233
v_add_f32 v74, v74, v70
v_add_f32 v75, v75, v71
v_lshlrev_b32 v70, 16, v234
v_and_b32 v71, 0xffff0000, v234
v_add_f32 v76, v76, v70
v_add_f32 v77, v77, v71
v_lshlrev_b32 v70, 16, v235
v_and_b32 v71, 0xffff0000, v235
v_add_f32 v78, v78, v70
v_add_f32 v79, v79, v71
s_waitcnt vmcnt(5)
v_lshlrev_b32 v70, 16, v236
v_and_b32 v71, 0xffff0000, v236
v_add_f32 v72, v72, v70
v_add_f32 v73, v73, v71
v_lshlrev_b32 v70, 16, v237
v_and_b32 v71, 0xffff0000, v237
v_add_f32 v74, v74, v70
v_add_f32 v75, v75, v71
v_lshlrev_b32 v70, 16, v238
v_and_b32 v71, 0xffff0000, v238
v_add_f32 v76, v76, v70
v_add_f32 v77, v77, v71
v_lshlrev_b32 v70, 16, v239
v_and_b32 v71, 0xffff0000, v239
v_add_f32 v78, v78, v70
v_add_f32 v79, v79, v71
s_waitcnt vmcnt(4)
v_lshlrev_b32 v70, 16, v240
v_and_b32 v71, 0xffff0000, v240
v_add_f32 v72, v72, v70
v_add_f32 v73, v73, v71
v_lshlrev_b32 v70, 16, v241
v_and_b32 v71, 0xffff0000, v241
v_add_f32 v74, v74, v70
v_add_f32 v75, v75, v71
v_lshlrev_b32 v70, 16, v242
v_and_b32 v71, 0xffff0000, v242
v_add_f32 v76, v76, v70
v_add_f32 v77, v77, v71
v_lshlrev_b32 v70, 16, v243
v_and_b32 v71, 0xffff0000, v243
v_add_f32 v78, v78, v70
v_add_f32 v79, v79, v71
s_waitcnt vmcnt(3)
v_lshlrev_b32 v70, 16, v244
v_and_b32 v71, 0xffff0000, v244
v_add_f32 v72, v72, v70
v_add_f32 v73, v73, v71
v_lshlrev_b32 v70, 16, v245
v_and_b32 v71, 0xffff0000, v245
v_add_f32 v74, v74, v70
v_add_f32 v75, v75, v71
v_lshlrev_b32 v70, 16, v246
v_and_b32 v71, 0xffff0000, v246
v_add_f32 v76, v76, v70
v_add_f32 v77, v77, v71
v_lshlrev_b32 v70, 16, v247
v_and_b32 v71, 0xffff0000, v247
v_add_f32 v78, v78, v70
v_add_f32 v79, v79, v71
s_waitcnt vmcnt(2)
v_lshlrev_b32 v70, 16, v248
v_and_b32 v71, 0xffff0000, v248
v_add_f32 v72, v72, v70
v_add_f32 v73, v73, v71
v_lshlrev_b32 v70, 16, v249
v_and_b32 v71, 0xffff0000, v249
v_add_f32 v74, v74, v70
v_add_f32 v75, v75, v71
v_lshlrev_b32 v70, 16, v250
v_and_b32 v71, 0xffff0000, v250
v_add_f32 v76, v76, v70
v_add_f32 v77, v77, v71
v_lshlrev_b32 v70, 16, v251
v_and_b32 v71, 0xffff0000, v251
v_add_f32 v78, v78, v70
v_add_f32 v79, v79, v71
s_waitcnt vmcnt(1)
v_lshlrev_b32 v70, 16, v252
v_and_b32 v71, 0xffff0000, v252
v_add_f32 v72, v72, v70
v_add_f32 v73, v73, v71
v_lshlrev_b32 v70, 16, v253
v_and_b32 v71, 0xffff0000, v253
v_add_f32 v74, v74, v70
v_add_f32 v75, v75, v71
v_lshlrev_b32 v70, 16, v254
v_and_b32 v71, 0xffff0000, v254
v_add_f32 v76, v76, v70
v_add_f32 v77, v77, v71
v_lshlrev_b32 v70, 16, v255
v_and_b32 v71, 0xffff0000, v255
v_add_f32 v78, v78, v70
v_add_f32 v79, v79, v71
v_cvt_pk_bf16_f32 v84, v72, v73
v_cvt_pk_bf16_f32 v85, v74, v75
v_cvt_pk_bf16_f32 v86, v76, v77
v_cvt_pk_bf16_f32 v87, v78, v79
buffer_store_dwordx4 v[84:87], v4, s[84:87], 0 offen offset:32
L_fin:
L_main_end:
s_endpgm
.section .rodata,"a"
.p2align 6
.amdhsa_kernel concat_heads__gqa_block_cached__gqa_block_cached__near_ridge_kernel
  .amdhsa_next_free_vgpr 512
  .amdhsa_next_free_sgpr 102
  .amdhsa_accum_offset 256
  .amdhsa_group_segment_fixed_size 0
  .amdhsa_kernarg_size 104
  .amdhsa_user_sgpr_count 2
  .amdhsa_user_sgpr_kernarg_segment_ptr 1
  .amdhsa_system_sgpr_workgroup_id_x 1
.end_amdhsa_kernel
```
